```python
import torch

def _softmax(x, axis=-1):
    return torch.softmax(x, dim=axis)
def _gelu(x):
    return torch.nn.functional.gelu(x, approximate="tanh")
def _silu(x):
    return torch.nn.functional.silu(x)
def _sigmoid(x):
    return torch.sigmoid(x)
def _layernorm(x, axis=-1, eps=1e-5):
    m = x.mean(dim=axis, keepdim=True)
    v = x.var(dim=axis, keepdim=True, unbiased=False)
    return (x - m) / torch.sqrt(v + eps)
def _scatter_add(tgt, idx, src, axis=0):
    return tgt.clone().index_add_(axis, idx, src)
def _segment_sum(src, seg, n):
    out = torch.zeros((n,) + src.shape[1:], dtype=src.dtype)
    return out.index_add_(0, seg, src)
def _pad(x, pw):
    flat = tuple(v for pair in reversed(pw) for v in pair)
    return torch.nn.functional.pad(x, flat)

kernel_name = 'sequential_preLN__gqa_block_cached__geglu_ffn__decode'

def setup_inputs():

    _w = (lambda a: (lambda t: t.to(torch.bfloat16) if t.is_floating_point() else t)(torch.as_tensor(a)))
    def _A_setup():
        B, Sq, D = 8, 1, 512
        Hq, Hkv, Sk, Dh = 32, 8, 8192, 128
        assert Hq % Hkv == 0, (Hq, Hkv)
        return {
            "x": _w((lambda *s: torch.randn(*s, dtype=torch.bfloat16) * 0.05)(B, Sq, D)),
            "k_cache": _w((lambda *s: torch.randn(*s, dtype=torch.bfloat16) * 3.2)(B, Hkv, Sk, Dh)),
            "v_cache": _w((lambda *s: torch.randn(*s, dtype=torch.bfloat16) * 0.4)(B, Hkv, Sk, Dh)),
            "wq": _w((lambda *s: torch.randn(*s, dtype=torch.bfloat16) * 3.2)(D, Hq * Dh) * (D ** -0.5)),
            "wo": _w((lambda *s: torch.randn(*s, dtype=torch.bfloat16) * 0.4)(Hq * Dh, D) * ((Hq * Dh) ** -0.5)),
        }
    _A_in = _A_setup()

    def _B_setup():
        B, S, D, F = 8, 1, 512, 1792
        return {
            "x": _w((lambda *s: torch.randn(*s, dtype=torch.bfloat16) * 0.05)(B, S, D)),
            "w_gate": _w((lambda *s: torch.randn(*s, dtype=torch.bfloat16) * 0.05)(D, F)),
            "w_up": _w((lambda *s: torch.randn(*s, dtype=torch.bfloat16) * 0.05)(D, F)),
            "w_down": _w((lambda *s: torch.randn(*s, dtype=torch.bfloat16) * 0.05)(F, D)),
        }
    _B_in = _B_setup()

    return {
        "A_x": _A_in["x"],
        "A_k_cache": _A_in["k_cache"],
        "A_v_cache": _A_in["v_cache"],
        "A_wq": _A_in["wq"],
        "A_wo": _A_in["wo"],
        "B_x": _B_in["x"],
        "B_w_gate": _B_in["w_gate"],
        "B_w_up": _B_in["w_up"],
        "B_w_down": _B_in["w_down"],
    }

def reference(A_x, A_k_cache, A_v_cache, A_wq, A_wo, B_x, B_w_gate, B_w_up, B_w_down):
    def _A_ref(x, k_cache, v_cache, wq, wo):
        B, Sq, D = x.shape
        Hq, Dh = 32, 128
        Hkv = k_cache.shape[1]
        rep = Hq // Hkv
        q = (lambda x, *d: x.permute(*d))((x @ wq).reshape(B, Sq, Hq, Dh), 0, 2, 1, 3)
        k = (lambda x, n, axis: torch.repeat_interleave(x, n, dim=axis))(k_cache, rep, axis=1)
        v = (lambda x, n, axis: torch.repeat_interleave(x, n, dim=axis))(v_cache, rep, axis=1)
        scores = torch.einsum("bhqd,bhkd->bhqk", q, k) * (Dh ** -0.5)
        p = _softmax(scores, axis=-1)
        o = torch.einsum("bhqk,bhkd->bhqd", p, v)
        return (lambda x, *d: x.permute(*d))(o, 0, 2, 1, 3).reshape(B, Sq, Hq * Dh) @ wo

    def _B_ref(x, w_gate, w_up, w_down):
        return (_gelu(x @ w_gate) * (x @ w_up)) @ w_down

    x = A_x
    h = x + _A_ref(_layernorm(x, axis=-1), A_k_cache, A_v_cache, A_wq, A_wo)
    h2 = h + _B_ref(_layernorm(h, axis=-1), B_w_gate, B_w_up, B_w_down)
    return h2
```

```asm
; @launch grid=(256,1,1) block=(256,1,1) lds=141568
.amdgcn_target "amdgcn-amd-amdhsa--gfx950"
.text
.globl sequential_preLN__gqa_block_cached__geglu_ffn__decode_kernel
.p2align 8
.type sequential_preLN__gqa_block_cached__geglu_ffn__decode_kernel,@function
sequential_preLN__gqa_block_cached__geglu_ffn__decode_kernel:
    s_cmp_ge_u32 s2, 256
    s_cbranch_scc1 L_end
    s_load_dwordx8 s[4:11], s[0:1], 0
    s_load_dwordx8 s[12:19], s[0:1], 32
    s_load_dwordx8 s[20:27], s[0:1], 64
    v_lshrrev_b32 v125, 6, v0
    v_and_b32 v1, 63, v0
    v_readfirstlane_b32 s3, v125
    v_lshrrev_b32 v142, 4, v1
    v_and_b32 v128, 14, v0
    v_lshlrev_b32 v2, 7, v128
    v_lshl_or_b32 v2, v142, 4, v2
    v_and_b32 v129, 1, v0
    v_lshl_or_b32 v2, v129, 6, v2
    v_xor_b32 v3, 64, v2
    s_mov_b32 s31, 0x20000
    s_and_b32 s99, s2, 7
    s_lshl_b32 s99, s99, 2
    s_bfe_u32 s75, s2, 0x20003
    s_or_b32 s99, s99, s75
    s_and_b32 s74, s2, 0xe0
    s_or_b32 s99, s99, s74
    s_lshr_b32 s74, s2, 5
    s_add_u32 s74, s75, s74
    s_and_b32 s100, s74, 3
    s_add_u32 s74, s74, 3
    s_and_b32 s74, s74, 3
    s_mov_b32 s98, s74
    s_lshl_b32 s101, s74, 15
    s_and_b32 s73, s3, 1
    s_lshl_b32 s73, s73, 12
    s_lshr_b32 s74, s3, 1
    s_lshl_b32 s74, s74, 13
    s_add_u32 s73, s73, s74
    s_lshr_b32 s75, s99, 2
    s_lshl_b32 s75, s75, 21
    s_sub_u32 s30, 0x200000, s73
    s_add_u32 s73, s73, s75
    s_waitcnt lgkmcnt(0)
    s_add_u32 s28, s6, s73
    s_addc_u32 s29, s7, 0
    s_and_b32 s29, s29, 0xffff
    s_cmp_eq_u32 s100, 0
    s_cbranch_scc1 L_A
    s_add_u32 s72, s101, 0
    buffer_load_dwordx4 a[0:3], v2, s[28:31], s72 offen offset:0 nt
    buffer_load_dwordx4 a[4:7], v2, s[28:31], s72 offen offset:128 nt
    s_load_dword s6, s[26:27], 262144
    buffer_load_dwordx4 a[8:11], v2, s[28:31], s72 offen offset:2048 nt
    buffer_load_dwordx4 a[12:15], v2, s[28:31], s72 offen offset:2176 nt
    s_add_u32 s72, s101, 16384
    buffer_load_dwordx4 a[16:19], v3, s[28:31], s72 offen offset:0 nt
    buffer_load_dwordx4 a[20:23], v3, s[28:31], s72 offen offset:128 nt
    buffer_load_dwordx4 a[24:27], v3, s[28:31], s72 offen offset:2048 nt
    buffer_load_dwordx4 a[28:31], v3, s[28:31], s72 offen offset:2176 nt
    s_and_b32 s74, s2, 120
    s_cmp_lg_u32 s74, 8
    s_cbranch_scc1 L_B
    s_getpc_b64 s[0:1]
    v_lshlrev_b32 v255, 5, v0
    global_load_dword v228, v255, s[0:1]
    s_branch L_B
L_A:
    s_load_dword s6, s[26:27], 262144
    s_mov_b32 s40, s4
    s_and_b32 s41, s5, 0xffff
    s_mov_b32 s42, 8192
    s_mov_b32 s43, 0x20000
    v_lshrrev_b32 v127, 5, v0
    v_and_b32 v129, 31, v0
    v_lshlrev_b32 v129, 4, v129
    v_lshl_or_b32 v125, v127, 10, v129
    buffer_load_dwordx4 v[156:159], v125, s[40:43], 0 offen
    buffer_load_dwordx4 v[160:163], v125, s[40:43], 0 offen offset:512
    s_mov_b32 s44, s10
    s_and_b32 s45, s11, 0xffff
    s_mov_b32 s46, 4194304
    s_mov_b32 s47, 0x20000
    v_and_b32 v128, 7, v0
    v_lshrrev_b32 v126, 3, v1
    v_and_b32 v130, 2, v126
    v_xor_b32 v128, v128, v130
    v_lshlrev_b32 v126, 13, v126
    v_lshl_or_b32 v126, v128, 4, v126
    v_xor_b32 v128, 64, v126
    s_and_b32 s74, s2, 7
    s_lshl_b32 s74, s74, 3
    s_lshr_b32 s75, s2, 5
    s_add_u32 s1, s74, s75
    s_xor_b32 s1, s1, 4
    s_lshl_b32 s74, s1, 7
    s_lshl_b32 s75, s3, 20
    s_add_u32 s74, s74, s75
    s_lshl_b32 s75, s3, 14
    s_add_u32 m0, s75, 43264
    s_nop 0
    buffer_load_dwordx4 v126, s[44:47], s74 offen nt lds
    s_add_u32 s74, s74, 65536
    s_add_u32 m0, m0, 1024
    s_nop 0
    buffer_load_dwordx4 v128, s[44:47], s74 offen nt lds
    s_add_u32 s74, s74, 65536
    s_add_u32 m0, m0, 1024
    s_mov_b32 s36, s26
    s_and_b32 s37, s27, 0xffff
    s_mov_b32 s38, 2605056
    s_mov_b32 s39, 0x20000
    s_waitcnt lgkmcnt(0)
    s_add_u32 s6, s6, 1
    v_mov_b32 v7, s6
    s_getreg_b32 s95, hwreg(HW_REG_XCC_ID, 0, 4)
    s_lshl_b32 s95, s95, 28
    s_xor_b32 s95, s95, s6
    s_cmp_lg_u32 s3, 1
    s_cbranch_scc1 L_xp1
    s_and_b32 s7, s2, 7
    s_lshl_b32 s7, s7, 7
    s_lshr_b32 s0, s2, 3
    s_lshl_b32 s0, s0, 2
    s_add_u32 s7, s7, s0
    s_add_u32 s7, s7, 327680
    v_mov_b32 v135, s95
    v_mov_b32 v136, 0
    s_mov_b64 exec, 1
    buffer_store_dword v135, v136, s[36:39], s7 offen
    s_mov_b64 exec, -1
L_xp1:
    buffer_load_dwordx4 v126, s[44:47], s74 offen nt lds
    s_add_u32 s74, s74, 65536
    s_add_u32 m0, m0, 1024
    s_nop 0
    buffer_load_dwordx4 v128, s[44:47], s74 offen nt lds
    s_add_u32 s74, s74, 65536
    s_add_u32 m0, m0, 1024
    s_nop 0
    buffer_load_dwordx4 v126, s[44:47], s74 offen nt lds
    s_add_u32 s74, s74, 65536
    s_add_u32 m0, m0, 1024
    s_nop 0
    buffer_load_dwordx4 v128, s[44:47], s74 offen nt lds
    s_add_u32 s74, s74, 65536
    s_add_u32 m0, m0, 1024
    s_nop 0
    buffer_load_dwordx4 v126, s[44:47], s74 offen nt lds
    s_add_u32 s74, s74, 65536
    s_add_u32 m0, m0, 1024
    s_nop 0
    buffer_load_dwordx4 v128, s[44:47], s74 offen nt lds
    s_add_u32 s74, s74, 65536
    s_add_u32 m0, m0, 1024
    s_nop 0
    buffer_load_dwordx4 v126, s[44:47], s74 offen nt lds
    s_add_u32 s74, s74, 65536
    s_add_u32 m0, m0, 1024
    s_nop 0
    buffer_load_dwordx4 v128, s[44:47], s74 offen nt lds
    s_add_u32 s74, s74, 65536
    s_add_u32 m0, m0, 1024
    s_nop 0
    buffer_load_dwordx4 v126, s[44:47], s74 offen nt lds
    s_add_u32 s74, s74, 65536
    s_add_u32 m0, m0, 1024
    s_nop 0
    buffer_load_dwordx4 v128, s[44:47], s74 offen nt lds
    s_add_u32 s74, s74, 65536
    s_add_u32 m0, m0, 1024
    s_nop 0
    buffer_load_dwordx4 v126, s[44:47], s74 offen nt lds
    s_add_u32 s74, s74, 65536
    s_add_u32 m0, m0, 1024
    s_nop 0
    buffer_load_dwordx4 v128, s[44:47], s74 offen nt lds
    s_add_u32 s74, s74, 65536
    s_add_u32 m0, m0, 1024
    s_nop 0
    buffer_load_dwordx4 v126, s[44:47], s74 offen nt lds
    s_add_u32 s74, s74, 65536
    s_add_u32 m0, m0, 1024
    s_nop 0
    buffer_load_dwordx4 v128, s[44:47], s74 offen nt lds
    v_lshlrev_b32 v4, 4, v1
    v_and_b32 v141, 15, v0
    s_add_u32 s32, s8, s73
    s_addc_u32 s33, s9, 0
    s_and_b32 s33, s33, 0xffff
    s_mov_b32 s34, s30
    s_mov_b32 s35, 0x20000
    s_mov_b32 s39, 0x20000
    s_mov_b32 s43, 0x20000
    s_mov_b32 s51, 0x20000
    s_mov_b32 s55, 0x20000
    s_mov_b32 s59, 0x20000
    s_mov_b32 s63, 0x20000
    s_mov_b32 s40, s4
    s_and_b32 s41, s5, 0xffff
    s_mov_b32 s42, 8192
    s_mov_b32 s36, s26
    s_and_b32 s37, s27, 0xffff
    s_mov_b32 s38, 2605056
    s_mov_b32 s5, 0xffff0000
    s_mov_b32 s78, 0xff00ff00
    s_mov_b32 s79, 0xff00ff00
    s_lshr_b32 s8, s2, 5
    s_cmp_lt_u32 s8, 7
    s_cselect_b32 s73, 1, 0
    s_cmp_eq_u32 s100, 3
    s_cselect_b32 s73, 3, s73
    s_cmp_eq_u32 s100, 2
    s_cselect_b32 s73, 2, s73
    s_cmp_eq_u32 s100, 1
    s_cselect_b32 s73, 3, s73
    s_mov_b32 s75, s8
    v_mul_u32_u24 v127, 1056, v127
    v_add_u32 v127, v127, v129
    s_waitcnt vmcnt(16)
    v_lshlrev_b32 v164, 16, v156
    v_and_b32 v165, s5, v156
    v_lshlrev_b32 v166, 16, v157
    v_and_b32 v167, s5, v157
    v_lshlrev_b32 v168, 16, v158
    v_and_b32 v169, s5, v158
    v_lshlrev_b32 v170, 16, v159
    v_and_b32 v171, s5, v159
    v_lshlrev_b32 v172, 16, v160
    v_and_b32 v173, s5, v160
    v_lshlrev_b32 v174, 16, v161
    v_and_b32 v175, s5, v161
    v_lshlrev_b32 v176, 16, v162
    v_and_b32 v177, s5, v162
    v_lshlrev_b32 v178, 16, v163
    v_and_b32 v179, s5, v163
    v_pk_add_f32 v[180:181], v[164:165], v[172:173]
    v_pk_add_f32 v[182:183], v[166:167], v[174:175]
    v_pk_add_f32 v[184:185], v[168:169], v[176:177]
    v_pk_add_f32 v[186:187], v[170:171], v[178:179]
    v_pk_add_f32 v[180:181], v[180:181], v[184:185]
    v_pk_add_f32 v[182:183], v[182:183], v[186:187]
    v_pk_add_f32 v[180:181], v[180:181], v[182:183]
    v_add_f32 v130, v180, v181
    s_nop 1
    v_add_f32_dpp v130, v130, v130 row_ror:8 row_mask:0xf bank_mask:0xf
    s_nop 1
    v_add_f32_dpp v130, v130, v130 row_ror:4 row_mask:0xf bank_mask:0xf
    s_nop 1
    v_add_f32_dpp v130, v130, v130 row_ror:2 row_mask:0xf bank_mask:0xf
    s_nop 1
    v_add_f32_dpp v130, v130, v130 row_ror:1 row_mask:0xf bank_mask:0xf
    v_mov_b32 v131, v130
    s_nop 1
    v_permlane16_swap_b32 v130, v131
    v_add_f32 v130, v130, v131
    v_mul_f32 v130, 0x3b000000, v130
    v_sub_f32 v180, v164, v130
    v_sub_f32 v181, v165, v130
    v_sub_f32 v182, v166, v130
    v_sub_f32 v183, v167, v130
    v_sub_f32 v184, v168, v130
    v_sub_f32 v185, v169, v130
    v_sub_f32 v186, v170, v130
    v_sub_f32 v187, v171, v130
    v_sub_f32 v188, v172, v130
    v_sub_f32 v189, v173, v130
    v_sub_f32 v190, v174, v130
    v_sub_f32 v191, v175, v130
    v_sub_f32 v192, v176, v130
    v_sub_f32 v193, v177, v130
    v_sub_f32 v194, v178, v130
    v_sub_f32 v195, v179, v130
    v_pk_mul_f32 v[132:133], v[180:181], v[180:181]
    v_pk_fma_f32 v[132:133], v[182:183], v[182:183], v[132:133]
    v_pk_fma_f32 v[132:133], v[184:185], v[184:185], v[132:133]
    v_pk_fma_f32 v[132:133], v[186:187], v[186:187], v[132:133]
    v_pk_fma_f32 v[132:133], v[188:189], v[188:189], v[132:133]
    v_pk_fma_f32 v[132:133], v[190:191], v[190:191], v[132:133]
    v_pk_fma_f32 v[132:133], v[192:193], v[192:193], v[132:133]
    v_pk_fma_f32 v[132:133], v[194:195], v[194:195], v[132:133]
    v_add_f32 v132, v132, v133
    s_nop 1
    v_add_f32_dpp v132, v132, v132 row_ror:8 row_mask:0xf bank_mask:0xf
    s_nop 1
    v_add_f32_dpp v132, v132, v132 row_ror:4 row_mask:0xf bank_mask:0xf
    s_nop 1
    v_add_f32_dpp v132, v132, v132 row_ror:2 row_mask:0xf bank_mask:0xf
    s_nop 1
    v_add_f32_dpp v132, v132, v132 row_ror:1 row_mask:0xf bank_mask:0xf
    v_mov_b32 v131, v132
    s_nop 1
    v_permlane16_swap_b32 v132, v131
    v_add_f32 v132, v132, v131
    v_mul_f32 v132, 0x3b000000, v132
    v_cvt_pk_bf16_f32 v134, v130, v132
    v_lshlrev_b32 v133, 16, v134
    v_and_b32 v134, s5, v134
    v_add_f32 v134, 0x3727c5ac, v134
    v_cvt_pk_bf16_f32 v134, v134, v134
    v_lshlrev_b32 v134, 16, v134
    v_sqrt_f32 v134, v134
    s_nop 0
    v_cvt_pk_bf16_f32 v134, v134, v134
    v_lshlrev_b32 v134, 16, v134
    v_rcp_f32 v134, v134
    v_sub_f32 v164, v164, v133
    v_sub_f32 v165, v165, v133
    v_sub_f32 v166, v166, v133
    v_sub_f32 v167, v167, v133
    v_sub_f32 v168, v168, v133
    v_sub_f32 v169, v169, v133
    v_sub_f32 v170, v170, v133
    v_sub_f32 v171, v171, v133
    v_sub_f32 v172, v172, v133
    v_sub_f32 v173, v173, v133
    v_sub_f32 v174, v174, v133
    v_sub_f32 v175, v175, v133
    v_sub_f32 v176, v176, v133
    v_sub_f32 v177, v177, v133
    v_sub_f32 v178, v178, v133
    v_sub_f32 v179, v179, v133
    v_cvt_pk_bf16_f32 v156, v164, v165
    v_cvt_pk_bf16_f32 v157, v166, v167
    v_cvt_pk_bf16_f32 v158, v168, v169
    v_cvt_pk_bf16_f32 v159, v170, v171
    v_cvt_pk_bf16_f32 v160, v172, v173
    v_cvt_pk_bf16_f32 v161, v174, v175
    v_cvt_pk_bf16_f32 v162, v176, v177
    v_cvt_pk_bf16_f32 v163, v178, v179
    v_lshlrev_b32 v164, 16, v156
    v_and_b32 v165, s5, v156
    v_lshlrev_b32 v166, 16, v157
    v_and_b32 v167, s5, v157
    v_lshlrev_b32 v168, 16, v158
    v_and_b32 v169, s5, v158
    v_lshlrev_b32 v170, 16, v159
    v_and_b32 v171, s5, v159
    v_lshlrev_b32 v172, 16, v160
    v_and_b32 v173, s5, v160
    v_lshlrev_b32 v174, 16, v161
    v_and_b32 v175, s5, v161
    v_lshlrev_b32 v176, 16, v162
    v_and_b32 v177, s5, v162
    v_lshlrev_b32 v178, 16, v163
    v_and_b32 v179, s5, v163
    v_mul_f32 v164, v164, v134
    v_mul_f32 v165, v165, v134
    v_mul_f32 v166, v166, v134
    v_mul_f32 v167, v167, v134
    v_mul_f32 v168, v168, v134
    v_mul_f32 v169, v169, v134
    v_mul_f32 v170, v170, v134
    v_mul_f32 v171, v171, v134
    v_mul_f32 v172, v172, v134
    v_mul_f32 v173, v173, v134
    v_mul_f32 v174, v174, v134
    v_mul_f32 v175, v175, v134
    v_mul_f32 v176, v176, v134
    v_mul_f32 v177, v177, v134
    v_mul_f32 v178, v178, v134
    v_mul_f32 v179, v179, v134
    v_cvt_pk_bf16_f32 v156, v164, v165
    v_cvt_pk_bf16_f32 v157, v166, v167
    v_cvt_pk_bf16_f32 v158, v168, v169
    v_cvt_pk_bf16_f32 v159, v170, v171
    v_cvt_pk_bf16_f32 v160, v172, v173
    v_cvt_pk_bf16_f32 v161, v174, v175
    v_cvt_pk_bf16_f32 v162, v176, v177
    v_cvt_pk_bf16_f32 v163, v178, v179
    ds_write_b128 v127, v[156:159] offset:0
    ds_write_b128 v127, v[160:163] offset:512
    v_and_b32 v128, 7, v0
    v_mul_u32_u24 v125, 1056, v128
    v_lshl_add_u32 v125, v142, 4, v125
    v_lshrrev_b32 v126, 2, v141
    v_lshl_add_u32 v126, v142, 3, v126
    v_lshlrev_b32 v126, 7, v126
    v_and_b32 v128, 3, v0
    v_lshl_add_u32 v126, v128, 3, v126
    v_bfe_u32 v128, v0, 3, 2
    v_xor_b32 v128, s3, v128
    v_lshl_add_u32 v126, v128, 5, v126
    v_add_u32 v126, 43264, v126
    v_lshlrev_b32 v127, 14, v141
    v_lshl_add_u32 v127, v142, 4, v127
    s_lshl_b32 s7, s3, 6
    s_lshl_b32 s9, s1, 8
    s_add_u32 s9, s7, s9
    v_mov_b32 v113, v7
    v_mov_b32 v115, v7
    s_waitcnt vmcnt(0) lgkmcnt(0)
    v_and_b32 v135, 31, v0
    v_lshlrev_b32 v135, 2, v135
    s_and_b32 s8, s2, 7
    s_lshl_b32 s8, s8, 7
    s_add_u32 s8, s8, 327680
    buffer_load_dword v137, v135, s[36:39], s8 offen sc1
    s_barrier
    ds_read_b128 a[0:3], v125 offset:0
    ds_read_b64_tr_b16 a[64:65], v126 offset:0
    ds_read_b64_tr_b16 a[66:67], v126 offset:512
    ds_read_b128 a[4:7], v125 offset:64
    ds_read_b64_tr_b16 a[68:69], v126 offset:4096
    ds_read_b64_tr_b16 a[70:71], v126 offset:4608
    ds_read_b128 a[8:11], v125 offset:128
    ds_read_b64_tr_b16 a[72:73], v126 offset:8192
    ds_read_b64_tr_b16 a[74:75], v126 offset:8704
    ds_read_b128 a[12:15], v125 offset:192
    ds_read_b64_tr_b16 a[76:77], v126 offset:12288
    ds_read_b64_tr_b16 a[78:79], v126 offset:12800
    s_waitcnt lgkmcnt(6)
    v_mfma_f32_16x16x32_bf16 v[108:111], a[64:67], a[0:3], 0
    v_mfma_f32_16x16x32_bf16 v[108:111], a[68:71], a[4:7], v[108:111]
    ds_read_b128 a[16:19], v125 offset:256
    ds_read_b64_tr_b16 a[80:81], v126 offset:16384
    ds_read_b64_tr_b16 a[82:83], v126 offset:16896
    ds_read_b128 a[20:23], v125 offset:320
    ds_read_b64_tr_b16 a[84:85], v126 offset:20480
    ds_read_b64_tr_b16 a[86:87], v126 offset:20992
    s_waitcnt lgkmcnt(6)
    v_mfma_f32_16x16x32_bf16 v[108:111], a[72:75], a[8:11], v[108:111]
    v_mfma_f32_16x16x32_bf16 v[108:111], a[76:79], a[12:15], v[108:111]
    ds_read_b128 a[24:27], v125 offset:384
    ds_read_b64_tr_b16 a[88:89], v126 offset:24576
    ds_read_b64_tr_b16 a[90:91], v126 offset:25088
    ds_read_b128 a[28:31], v125 offset:448
    ds_read_b64_tr_b16 a[92:93], v126 offset:28672
    ds_read_b64_tr_b16 a[94:95], v126 offset:29184
    s_waitcnt lgkmcnt(6)
    v_mfma_f32_16x16x32_bf16 v[108:111], a[80:83], a[16:19], v[108:111]
    v_mfma_f32_16x16x32_bf16 v[108:111], a[84:87], a[20:23], v[108:111]
    ds_read_b128 a[32:35], v125 offset:512
    ds_read_b64_tr_b16 a[96:97], v126 offset:32768
    ds_read_b64_tr_b16 a[98:99], v126 offset:33280
    ds_read_b128 a[36:39], v125 offset:576
    ds_read_b64_tr_b16 a[100:101], v126 offset:36864
    ds_read_b64_tr_b16 a[102:103], v126 offset:37376
    s_waitcnt lgkmcnt(6)
    v_mfma_f32_16x16x32_bf16 v[108:111], a[88:91], a[24:27], v[108:111]
    v_mfma_f32_16x16x32_bf16 v[108:111], a[92:95], a[28:31], v[108:111]
    ds_read_b128 a[40:43], v125 offset:640
    ds_read_b64_tr_b16 a[104:105], v126 offset:40960
    ds_read_b64_tr_b16 a[106:107], v126 offset:41472
    ds_read_b128 a[44:47], v125 offset:704
    ds_read_b64_tr_b16 a[108:109], v126 offset:45056
    ds_read_b64_tr_b16 a[110:111], v126 offset:45568
    s_waitcnt lgkmcnt(6)
    v_mfma_f32_16x16x32_bf16 v[108:111], a[96:99], a[32:35], v[108:111]
    v_mfma_f32_16x16x32_bf16 v[108:111], a[100:103], a[36:39], v[108:111]
    ds_read_b128 a[48:51], v125 offset:768
    ds_read_b64_tr_b16 a[112:113], v126 offset:49152
    ds_read_b64_tr_b16 a[114:115], v126 offset:49664
    ds_read_b128 a[52:55], v125 offset:832
    ds_read_b64_tr_b16 a[116:117], v126 offset:53248
    ds_read_b64_tr_b16 a[118:119], v126 offset:53760
    s_waitcnt lgkmcnt(6)
    v_mfma_f32_16x16x32_bf16 v[108:111], a[104:107], a[40:43], v[108:111]
    v_mfma_f32_16x16x32_bf16 v[108:111], a[108:111], a[44:47], v[108:111]
    ds_read_b128 a[56:59], v125 offset:896
    ds_read_b64_tr_b16 a[120:121], v126 offset:57344
    ds_read_b64_tr_b16 a[122:123], v126 offset:57856
    ds_read_b128 a[60:63], v125 offset:960
    ds_read_b64_tr_b16 a[124:125], v126 offset:61440
    ds_read_b64_tr_b16 a[126:127], v126 offset:61952
    s_waitcnt lgkmcnt(6)
    v_mfma_f32_16x16x32_bf16 v[108:111], a[112:115], a[48:51], v[108:111]
    v_mfma_f32_16x16x32_bf16 v[108:111], a[116:119], a[52:55], v[108:111]
    s_waitcnt lgkmcnt(0)
    v_mfma_f32_16x16x32_bf16 v[108:111], a[120:123], a[56:59], v[108:111]
    v_mfma_f32_16x16x32_bf16 v[108:111], a[124:127], a[60:63], v[108:111]
    s_nop 7
    v_cvt_pk_bf16_f32 v112, v108, v109
    v_cvt_pk_bf16_f32 v114, v110, v111
    s_waitcnt vmcnt(0)
    v_cmp_ne_u32 s[0:1], s95, v137
    s_cmp_eq_u64 s[0:1], 0
    s_cselect_b32 s96, 1, 0
    s_not_b64 exec, s[78:79]
    s_cmp_eq_u32 s96, 0
    s_cbranch_scc1 L_ls2
    buffer_store_dwordx4 v[112:115], v127, s[36:39], s9 offen
L_le2:
    s_mov_b64 exec, -1
    s_mov_b32 s8, s75
    s_mov_b32 s48, s12
    s_and_b32 s49, s13, 0xffff
    s_mov_b32 s50, 4194304
    s_mov_b32 s52, s16
    s_and_b32 s53, s17, 0xffff
    s_mov_b32 s54, 1835008
    s_mov_b32 s56, s18
    s_and_b32 s57, s19, 0xffff
    s_mov_b32 s58, 1835008
    s_mov_b32 s60, s20
    s_and_b32 s61, s21, 0xffff
    s_mov_b32 s62, 1835008
    s_mov_b64 s[18:19], s[22:23]
    s_mov_b32 s75, 0x3fb8aa3b
    s_mov_b32 s4, 0x3db504f3
    s_mov_b32 s74, 0
    s_mov_b32 s15, 0xff
    s_bfe_u32 s12, s2, 0x30003
    s_and_b32 s7, s2, 7
    s_mul_i32 s10, s7, 7
    s_add_u32 s10, s10, s8
    s_lshl_b32 s11, s7, 2
    s_lshr_b32 s7, s2, 6
    s_add_u32 s11, s11, s7
    s_mov_b32 s76, 0xaaaa5555
    s_mov_b32 s77, 0xaaaa5555
    s_cmp_eq_u32 s73, 1
    s_cselect_b32 s54, s54, 0
    s_cselect_b32 s58, s58, 0
    s_cselect_b32 s62, s62, 0
    s_cmp_eq_u32 s100, 0
    s_cselect_b32 s24, -1, 0
    s_mov_b32 s25, s24
    v_lshrrev_b32 v240, 3, v1
    v_and_b32 v126, 2, v240
    v_lshlrev_b32 v240, 10, v240
    v_and_b32 v125, 7, v0
    v_xor_b32 v125, v125, v126
    v_lshl_or_b32 v240, v125, 4, v240
    v_xor_b32 v244, 64, v240
    v_lshrrev_b32 v125, 2, v1
    v_mul_u32_u24 v224, 3584, v125
    v_and_b32 v126, 3, v0
    v_and_b32 v125, 2, v142
    v_xor_b32 v126, v126, v125
    v_lshl_add_u32 v224, v126, 4, v224
    v_xor_b32 v225, 16, v224
    v_lshlrev_b32 v253, 10, v142
    v_lshlrev_b32 v125, 1, v142
    v_xor_b32 v125, v125, v141
    v_lshl_or_b32 v253, v125, 4, v253
    v_xor_b32 v254, 128, v253
    s_mul_i32 s46, s3, 458752
    s_lshl_b32 s8, s10, 6
    s_add_u32 s46, s46, s8
    s_lshl_b32 s47, s3, 14
    s_add_u32 s47, s47, 43264
    s_lshl_b32 s44, s11, 17
    s_lshl_b32 s8, s12, 7
    s_add_u32 s44, s44, s8
    s_lshl_b32 s8, s3, 15
    s_add_u32 s44, s44, s8
    s_lshl_b32 s45, s3, 12
    s_add_u32 s45, s45, 26880
    v_and_b32 v125, 1, v0
    v_cmp_eq_u32 vcc, 1, v125
    v_mov_b32 v126, 0x0c0c0100
    v_mov_b32 v127, 0x01000c0c
    v_cndmask_b32 v126, v126, v127, vcc
    v_mov_b32 v127, 0x0c0c0302
    v_mov_b32 v128, 0x03020c0c
    v_cndmask_b32 v127, v127, v128, vcc
    v_bfe_u32 v125, v0, 1, 1
    v_bfe_u32 v128, v0, 3, 1
    v_lshl_or_b32 v125, v128, 1, v125
    v_mov_b32 v128, 0x0c0c0c0c
    v_cmp_eq_u32 vcc, 0, v125
    s_nop 1
    v_cndmask_b32 v8, v128, v126, vcc
    v_cndmask_b32 v12, v128, v127, vcc
    v_cmp_eq_u32 vcc, 1, v125
    s_nop 1
    v_cndmask_b32 v9, v128, v126, vcc
    v_cndmask_b32 v13, v128, v127, vcc
    v_cmp_eq_u32 vcc, 2, v125
    s_nop 1
    v_cndmask_b32 v10, v128, v126, vcc
    v_cndmask_b32 v14, v128, v127, vcc
    v_cmp_eq_u32 vcc, 3, v125
    s_nop 1
    v_cndmask_b32 v11, v128, v126, vcc
    v_cndmask_b32 v15, v128, v127, vcc
    s_mul_i32 s7, s3, 4608
    s_add_u32 s7, s7, 8448
    v_mov_b32 v252, 0xff800000
    v_bfe_u32 v125, v0, 4, 1
    v_lshlrev_b32 v5, 7, v125
    v_and_b32 v125, 7, v0
    v_lshl_or_b32 v5, v125, 4, v5
    v_bfe_u32 v125, v0, 5, 1
    v_lshl_or_b32 v5, v125, 3, v5
    v_bfe_u32 v125, v0, 3, 1
    v_lshl_or_b32 v5, v125, 2, v5
    v_add_u32 v5, s7, v5
    v_and_b32 v125, 4, v0
    v_lshlrev_b32 v6, 5, v125
    v_lshl_or_b32 v6, v142, 5, v6
    v_add_u32 v6, s7, v6
    v_mov_b32 v116, 0xff800000
    v_mov_b32 v117, 0xff800000
    v_mov_b32 v118, 0
    v_mov_b32 v119, 0
    s_lshl_b32 s7, s3, 11
    s_add_u32 s7, s7, 0
    v_bfe_u32 v125, v0, 4, 1
    v_lshlrev_b32 v232, 9, v125
    v_lshl_or_b32 v232, v141, 5, v232
    v_bfe_u32 v125, v0, 5, 1
    v_lshl_or_b32 v232, v125, 4, v232
    v_add_u32 v232, s7, v232
    v_lshlrev_b32 v233, 3, v0
    v_lshlrev_b32 v234, 2, v1
    v_lshlrev_b32 v235, 3, v1
    v_lshlrev_b32 v255, 4, v0
    s_and_b32 s7, s99, 28
    s_add_u32 s7, s7, s3
    s_lshl_b32 s13, s7, 14
    s_lshr_b32 s7, s99, 6
    s_lshl_b32 s7, s7, 12
    s_add_u32 s13, s13, s7
    s_and_b32 s7, s99, 3
    s_lshl_b32 s7, s7, 10
    s_add_u32 s13, s13, s7
    s_and_b32 s7, s99, 32
    s_lshl_b32 s7, s7, 4
    s_add_u32 s13, s13, s7
    s_add_u32 s13, s13, 1572864
    s_lshl_b32 s14, s11, 14
    s_lshl_b32 s7, s3, 12
    s_add_u32 s14, s14, s7
    s_add_u32 s14, s14, 1572864
    v_lshrrev_b32 v125, 5, v0
    v_and_b32 v126, 31, v0
    v_mul_u32_u24 v236, 288, v125
    v_lshl_add_u32 v236, v126, 3, v236
    v_and_b32 v125, 7, v0
    v_mul_u32_u24 v126, 288, v125
    v_lshl_add_u32 v126, v142, 4, v126
    v_add_u32 v237, 8448, v126
    v_lshlrev_b32 v239, 4, v125
    v_bfe_u32 v126, v0, 4, 1
    v_lshl_or_b32 v239, v126, 3, v239
    v_and_b32 v126, 32, v0
    v_lshl_or_b32 v239, v126, 7, v239
    v_cndmask_b32 v239, v239, v252, s[78:79]
    s_lshl_b32 s23, s12, 15
    s_lshl_b32 s7, s11, 7
    s_add_u32 s23, s23, s7
    s_lshl_b32 s7, s3, 13
    s_add_u32 s23, s23, s7
    s_add_u32 s23, s23, 1048576
    v_lshrrev_b32 v125, 2, v141
    v_lshl_add_u32 v125, v142, 3, v125
    v_and_b32 v126, 3, v0
    v_lshlrev_b32 v143, 7, v125
    v_lshl_or_b32 v143, v126, 3, v143
    v_bfe_u32 v126, v0, 3, 2
    v_xor_b32 v126, s3, v126
    v_lshl_or_b32 v143, v126, 5, v143
    v_add_u32 v143, 26880, v143
    v_and_b32 v250, s15, v7
    v_and_b32 v251, 1, v0
    v_add_u32 v251, s15, v251
    v_and_b32 v251, s15, v251
    s_mov_b32 s21, 0
    v_mov_b32 v243, 12800
    v_mov_b32 v125, 0
    ds_write_b32 v243, v125
    ds_write_b32 v243, v125 offset:4
    s_barrier
    s_branch L_J
L_B:
    v_lshlrev_b32 v4, 4, v1
    v_and_b32 v141, 15, v0
    s_add_u32 s32, s8, s73
    s_addc_u32 s33, s9, 0
    s_and_b32 s33, s33, 0xffff
    s_mov_b32 s34, s30
    s_mov_b32 s35, 0x20000
    s_mov_b32 s39, 0x20000
    s_mov_b32 s43, 0x20000
    s_mov_b32 s51, 0x20000
    s_mov_b32 s55, 0x20000
    s_mov_b32 s59, 0x20000
    s_mov_b32 s63, 0x20000
    s_mov_b32 s40, s4
    s_and_b32 s41, s5, 0xffff
    s_mov_b32 s42, 8192
    s_mov_b32 s36, s26
    s_and_b32 s37, s27, 0xffff
    s_mov_b32 s38, 2605056
    s_mov_b32 s5, 0xffff0000
    s_mov_b32 s78, 0xff00ff00
    s_mov_b32 s79, 0xff00ff00
    s_lshr_b32 s8, s2, 5
    s_cmp_lt_u32 s8, 7
    s_cselect_b32 s73, 1, 0
    s_cmp_eq_u32 s100, 3
    s_cselect_b32 s73, 3, s73
    s_cmp_eq_u32 s100, 2
    s_cselect_b32 s73, 2, s73
    s_cmp_eq_u32 s100, 1
    s_cselect_b32 s73, 3, s73
    s_mov_b32 s48, s12
    s_and_b32 s49, s13, 0xffff
    s_mov_b32 s50, 4194304
    s_mov_b32 s52, s16
    s_and_b32 s53, s17, 0xffff
    s_mov_b32 s54, 1835008
    s_mov_b32 s56, s18
    s_and_b32 s57, s19, 0xffff
    s_mov_b32 s58, 1835008
    s_mov_b32 s60, s20
    s_and_b32 s61, s21, 0xffff
    s_mov_b32 s62, 1835008
    s_mov_b64 s[18:19], s[22:23]
    s_mov_b32 s75, 0x3fb8aa3b
    s_mov_b32 s4, 0x3db504f3
    s_mov_b32 s74, 0
    s_mov_b32 s15, 0xff
    s_bfe_u32 s12, s2, 0x30003
    s_and_b32 s7, s2, 7
    s_mul_i32 s10, s7, 7
    s_add_u32 s10, s10, s8
    s_lshl_b32 s11, s7, 2
    s_lshr_b32 s7, s2, 6
    s_add_u32 s11, s11, s7
    s_mov_b32 s76, 0xaaaa5555
    s_mov_b32 s77, 0xaaaa5555
    s_cmp_eq_u32 s73, 1
    s_cselect_b32 s54, s54, 0
    s_cselect_b32 s58, s58, 0
    s_cselect_b32 s62, s62, 0
    s_cmp_eq_u32 s100, 0
    s_cselect_b32 s24, -1, 0
    s_mov_b32 s25, s24
    s_mov_b32 s21, 0
    v_mov_b32 v243, 12800
    v_mov_b32 v125, 0
    ds_write_b32 v243, v125
    ds_write_b32 v243, v125 offset:4
    s_waitcnt lgkmcnt(0)
    s_add_u32 s6, s6, 1
    v_mov_b32 v7, s6
    s_getreg_b32 s95, hwreg(HW_REG_XCC_ID, 0, 4)
    s_lshl_b32 s95, s95, 28
    s_xor_b32 s95, s95, s6
    s_cmp_lg_u32 s3, 1
    s_cbranch_scc1 L_xp3
    s_and_b32 s7, s2, 7
    s_lshl_b32 s7, s7, 7
    s_lshr_b32 s0, s2, 3
    s_lshl_b32 s0, s0, 2
    s_add_u32 s7, s7, s0
    s_add_u32 s7, s7, 327680
    v_mov_b32 v135, s95
    v_mov_b32 v136, 0
    s_mov_b64 exec, 1
    buffer_store_dword v135, v136, s[36:39], s7 offen
    s_mov_b64 exec, -1
L_xp3:
    s_add_u32 s72, s101, 98304
    s_waitcnt vmcnt(5)
    buffer_load_dwordx4 a[32:35], v2, s[28:31], s72 offen offset:0 nt
    v_lshrrev_b32 v240, 3, v1
    v_and_b32 v126, 2, v240
    v_lshlrev_b32 v240, 10, v240
    v_and_b32 v125, 7, v0
    v_xor_b32 v125, v125, v126
    v_lshl_or_b32 v240, v125, 4, v240
    v_xor_b32 v244, 64, v240
    v_lshrrev_b32 v125, 2, v1
    v_mul_u32_u24 v224, 3584, v125
    v_and_b32 v126, 3, v0
    v_and_b32 v125, 2, v142
    v_xor_b32 v126, v126, v125
    v_lshl_add_u32 v224, v126, 4, v224
    v_xor_b32 v225, 16, v224
    v_lshlrev_b32 v253, 10, v142
    v_lshlrev_b32 v125, 1, v142
    v_xor_b32 v125, v125, v141
    v_lshl_or_b32 v253, v125, 4, v253
    v_xor_b32 v254, 128, v253
    s_mul_i32 s46, s3, 458752
    s_lshl_b32 s8, s10, 6
    s_add_u32 s46, s46, s8
    s_lshl_b32 s47, s3, 14
    s_add_u32 s47, s47, 43264
    s_lshl_b32 s44, s11, 17
    s_lshl_b32 s8, s12, 7
    s_add_u32 s44, s44, s8
    s_lshl_b32 s8, s3, 15
    s_add_u32 s44, s44, s8
    s_lshl_b32 s45, s3, 12
    s_add_u32 s45, s45, 26880
    s_waitcnt vmcnt(5)
    buffer_load_dwordx4 a[36:39], v2, s[28:31], s72 offen offset:128 nt
    v_and_b32 v125, 1, v0
    v_cmp_eq_u32 vcc, 1, v125
    v_mov_b32 v126, 0x0c0c0100
    v_mov_b32 v127, 0x01000c0c
    v_cndmask_b32 v126, v126, v127, vcc
    v_mov_b32 v127, 0x0c0c0302
    v_mov_b32 v128, 0x03020c0c
    v_cndmask_b32 v127, v127, v128, vcc
    v_bfe_u32 v125, v0, 1, 1
    v_bfe_u32 v128, v0, 3, 1
    v_lshl_or_b32 v125, v128, 1, v125
    v_mov_b32 v128, 0x0c0c0c0c
    v_cmp_eq_u32 vcc, 0, v125
    s_nop 1
    v_cndmask_b32 v8, v128, v126, vcc
    v_cndmask_b32 v12, v128, v127, vcc
    v_cmp_eq_u32 vcc, 1, v125
    s_nop 1
    v_cndmask_b32 v9, v128, v126, vcc
    v_cndmask_b32 v13, v128, v127, vcc
    v_cmp_eq_u32 vcc, 2, v125
    s_nop 1
    v_cndmask_b32 v10, v128, v126, vcc
    v_cndmask_b32 v14, v128, v127, vcc
    v_cmp_eq_u32 vcc, 3, v125
    s_nop 1
    v_cndmask_b32 v11, v128, v126, vcc
    v_cndmask_b32 v15, v128, v127, vcc
    s_waitcnt vmcnt(5)
    buffer_load_dwordx4 a[40:43], v2, s[28:31], s72 offen offset:2048 nt
    s_mul_i32 s7, s3, 4608
    s_add_u32 s7, s7, 8448
    v_mov_b32 v252, 0xff800000
    v_bfe_u32 v125, v0, 4, 1
    v_lshlrev_b32 v5, 7, v125
    v_and_b32 v125, 7, v0
    v_lshl_or_b32 v5, v125, 4, v5
    v_bfe_u32 v125, v0, 5, 1
    v_lshl_or_b32 v5, v125, 3, v5
    v_bfe_u32 v125, v0, 3, 1
    v_lshl_or_b32 v5, v125, 2, v5
    v_add_u32 v5, s7, v5
    v_and_b32 v125, 4, v0
    v_lshlrev_b32 v6, 5, v125
    v_lshl_or_b32 v6, v142, 5, v6
    v_add_u32 v6, s7, v6
    v_mov_b32 v116, 0xff800000
    v_mov_b32 v117, 0xff800000
    v_mov_b32 v118, 0
    v_mov_b32 v119, 0
    s_waitcnt vmcnt(5)
    buffer_load_dwordx4 a[44:47], v2, s[28:31], s72 offen offset:2176 nt
    s_lshl_b32 s7, s3, 11
    s_add_u32 s7, s7, 0
    v_bfe_u32 v125, v0, 4, 1
    v_lshlrev_b32 v232, 9, v125
    v_lshl_or_b32 v232, v141, 5, v232
    v_bfe_u32 v125, v0, 5, 1
    v_lshl_or_b32 v232, v125, 4, v232
    v_add_u32 v232, s7, v232
    v_lshlrev_b32 v233, 3, v0
    v_lshlrev_b32 v234, 2, v1
    v_lshlrev_b32 v235, 3, v1
    v_lshlrev_b32 v255, 4, v0
    s_and_b32 s7, s99, 28
    s_add_u32 s7, s7, s3
    s_lshl_b32 s13, s7, 14
    s_lshr_b32 s7, s99, 6
    s_lshl_b32 s7, s7, 12
    s_add_u32 s13, s13, s7
    s_and_b32 s7, s99, 3
    s_lshl_b32 s7, s7, 10
    s_add_u32 s13, s13, s7
    s_and_b32 s7, s99, 32
    s_lshl_b32 s7, s7, 4
    s_add_u32 s13, s13, s7
    s_add_u32 s13, s13, 1572864
    s_lshl_b32 s14, s11, 14
    s_lshl_b32 s7, s3, 12
    s_add_u32 s14, s14, s7
    s_add_u32 s14, s14, 1572864
    s_add_u32 s72, s101, 114688
    s_waitcnt vmcnt(5)
    buffer_load_dwordx4 a[48:51], v3, s[28:31], s72 offen offset:0 nt
    v_lshrrev_b32 v125, 5, v0
    v_and_b32 v126, 31, v0
    v_mul_u32_u24 v236, 288, v125
    v_lshl_add_u32 v236, v126, 3, v236
    v_and_b32 v125, 7, v0
    v_mul_u32_u24 v126, 288, v125
    v_lshl_add_u32 v126, v142, 4, v126
    v_add_u32 v237, 8448, v126
    v_lshlrev_b32 v239, 4, v125
    v_bfe_u32 v126, v0, 4, 1
    v_lshl_or_b32 v239, v126, 3, v239
    v_and_b32 v126, 32, v0
    v_lshl_or_b32 v239, v126, 7, v239
    v_cndmask_b32 v239, v239, v252, s[78:79]
    s_lshl_b32 s23, s12, 15
    s_lshl_b32 s7, s11, 7
    s_add_u32 s23, s23, s7
    s_lshl_b32 s7, s3, 13
    s_add_u32 s23, s23, s7
    s_add_u32 s23, s23, 1048576
    v_lshrrev_b32 v125, 2, v141
    v_lshl_add_u32 v125, v142, 3, v125
    v_and_b32 v126, 3, v0
    v_lshlrev_b32 v143, 7, v125
    v_lshl_or_b32 v143, v126, 3, v143
    v_bfe_u32 v126, v0, 3, 2
    v_xor_b32 v126, s3, v126
    v_lshl_or_b32 v143, v126, 5, v143
    v_add_u32 v143, 26880, v143
    v_and_b32 v250, s15, v7
    v_and_b32 v251, 1, v0
    v_add_u32 v251, s15, v251
    v_and_b32 v251, s15, v251
    s_waitcnt vmcnt(5)
    buffer_load_dwordx4 a[52:55], v3, s[28:31], s72 offen offset:128 nt
    s_waitcnt vmcnt(5)
    buffer_load_dwordx4 a[56:59], v3, s[28:31], s72 offen offset:2048 nt
    s_waitcnt vmcnt(5)
    buffer_load_dwordx4 a[60:63], v3, s[28:31], s72 offen offset:2176 nt
    s_add_u32 s72, s101, 196608
    s_waitcnt vmcnt(5)
    buffer_load_dwordx4 a[64:67], v2, s[28:31], s72 offen offset:0 nt
    s_waitcnt vmcnt(5)
    buffer_load_dwordx4 a[68:71], v2, s[28:31], s72 offen offset:128 nt
    s_waitcnt vmcnt(5)
    buffer_load_dwordx4 a[72:75], v2, s[28:31], s72 offen offset:2048 nt
    s_waitcnt vmcnt(5)
    buffer_load_dwordx4 a[76:79], v2, s[28:31], s72 offen offset:2176 nt
    s_add_u32 s72, s101, 212992
    s_waitcnt vmcnt(5)
    buffer_load_dwordx4 a[80:83], v3, s[28:31], s72 offen offset:0 nt
    s_waitcnt vmcnt(5)
    buffer_load_dwordx4 a[84:87], v3, s[28:31], s72 offen offset:128 nt
    s_waitcnt vmcnt(5)
    buffer_load_dwordx4 a[88:91], v3, s[28:31], s72 offen offset:2048 nt
    s_waitcnt vmcnt(5)
    buffer_load_dwordx4 a[92:95], v3, s[28:31], s72 offen offset:2176 nt
    s_add_u32 s72, s101, 294912
    s_waitcnt vmcnt(5)
    buffer_load_dwordx4 a[96:99], v2, s[28:31], s72 offen offset:0 nt
    s_waitcnt vmcnt(5)
    buffer_load_dwordx4 a[100:103], v2, s[28:31], s72 offen offset:128 nt
    s_waitcnt vmcnt(5)
    buffer_load_dwordx4 a[104:107], v2, s[28:31], s72 offen offset:2048 nt
    s_waitcnt vmcnt(5)
    buffer_load_dwordx4 a[108:111], v2, s[28:31], s72 offen offset:2176 nt
    s_add_u32 s72, s101, 311296
    s_waitcnt vmcnt(5)
    buffer_load_dwordx4 a[112:115], v3, s[28:31], s72 offen offset:0 nt
    s_waitcnt vmcnt(5)
    buffer_load_dwordx4 a[116:119], v3, s[28:31], s72 offen offset:128 nt
    s_waitcnt vmcnt(5)
    buffer_load_dwordx4 a[120:123], v3, s[28:31], s72 offen offset:2048 nt
    s_waitcnt vmcnt(5)
    buffer_load_dwordx4 a[124:127], v3, s[28:31], s72 offen offset:2176 nt
L_J:
    s_add_u32 s72, s101, 393216
    s_waitcnt vmcnt(5)
    buffer_load_dwordx4 a[128:131], v2, s[28:31], s72 offen offset:0 nt
    s_waitcnt vmcnt(5)
    buffer_load_dwordx4 a[132:135], v2, s[28:31], s72 offen offset:128 nt
    s_lshr_b32 s7, s2, 3
    s_and_b32 s7, s7, 15
    s_cmp_lg_u32 s7, 0
    s_cbranch_scc1 L_nr0
    s_getpc_b64 s[0:1]
L_rp0:
    s_add_u32 s0, s0, 1536
    s_addc_u32 s1, s1, 0
    global_load_dwordx4 v[228:231], v255, s[0:1]
L_nr0:
    s_waitcnt vmcnt(5)
    buffer_load_dwordx4 a[136:139], v2, s[28:31], s72 offen offset:2048 nt
    s_waitcnt vmcnt(5)
    buffer_load_dwordx4 a[140:143], v2, s[28:31], s72 offen offset:2176 nt
    s_lshr_b32 s7, s2, 3
    s_and_b32 s7, s7, 15
    s_cmp_lg_u32 s7, 8
    s_cbranch_scc1 L_nr8
    s_getpc_b64 s[0:1]
L_rp8:
    s_add_u32 s0, s0, L_end-L_rp8
    s_addc_u32 s1, s1, 0
    global_load_dwordx4 v[228:231], v255, s[0:1]
L_nr8:
    s_add_u32 s72, s101, 409600
    s_waitcnt vmcnt(5)
    buffer_load_dwordx4 a[144:147], v3, s[28:31], s72 offen offset:0 nt
    s_waitcnt vmcnt(5)
    buffer_load_dwordx4 a[148:151], v3, s[28:31], s72 offen offset:128 nt
    s_waitcnt vmcnt(5)
    buffer_load_dwordx4 a[152:155], v3, s[28:31], s72 offen offset:2048 nt
    s_waitcnt vmcnt(5)
    buffer_load_dwordx4 a[156:159], v3, s[28:31], s72 offen offset:2176 nt
    s_add_u32 s72, s101, 524288
    s_waitcnt vmcnt(5)
    buffer_load_dwordx4 a[160:163], v2, s[28:31], s72 offen offset:0 nt
    s_waitcnt vmcnt(5)
    buffer_load_dwordx4 a[164:167], v2, s[28:31], s72 offen offset:128 nt
    s_waitcnt vmcnt(5)
    buffer_load_dwordx4 a[168:171], v2, s[28:31], s72 offen offset:2048 nt
    s_waitcnt vmcnt(5)
    buffer_load_dwordx4 a[172:175], v2, s[28:31], s72 offen offset:2176 nt
    s_add_u32 s72, s101, 540672
    s_waitcnt vmcnt(5)
    buffer_load_dwordx4 a[176:179], v3, s[28:31], s72 offen offset:0 nt
    s_waitcnt vmcnt(5)
    buffer_load_dwordx4 a[180:183], v3, s[28:31], s72 offen offset:128 nt
    s_waitcnt vmcnt(5)
    buffer_load_dwordx4 a[184:187], v3, s[28:31], s72 offen offset:2048 nt
    s_cmp_lg_u32 s3, 0
    s_cbranch_scc1 L_np0
    s_and_b32 s7, s2, 7
    s_mul_i32 s8, s7, 5
    s_lshr_b32 s22, s2, 3
    s_add_u32 s22, s22, s8
    s_add_u32 s22, s22, 0
    s_and_b32 s0, s22, 31
    s_and_b32 s22, s22, 31
    s_lshl_b32 s22, s22, 7
    s_add_u32 s22, s22, 393216
    s_load_dwordx8 s[64:71], s[26:27], s22 glc
    s_lshl_b32 s7, s7, 2
    s_xor_b32 s22, s22, 2048
    s_add_u32 s22, s22, s7
    s_atomic_swap s6, s[26:27], s22
L_np0:
    s_waitcnt vmcnt(5)
    buffer_load_dwordx4 a[188:191], v3, s[28:31], s72 offen offset:2176 nt
    s_add_u32 s72, s101, 655360
    s_waitcnt vmcnt(5)
    buffer_load_dwordx4 a[192:195], v2, s[28:31], s72 offen offset:0 nt
    s_waitcnt vmcnt(5)
    buffer_load_dwordx4 a[196:199], v2, s[28:31], s72 offen offset:128 nt
    s_waitcnt vmcnt(5)
    buffer_load_dwordx4 a[200:203], v2, s[28:31], s72 offen offset:2048 nt
    s_waitcnt vmcnt(5)
    buffer_load_dwordx4 a[204:207], v2, s[28:31], s72 offen offset:2176 nt
    s_add_u32 s72, s101, 671744
    s_waitcnt vmcnt(5)
    buffer_load_dwordx4 a[208:211], v3, s[28:31], s72 offen offset:0 nt
    v_and_b32 v138, 3, v0
    v_lshlrev_b32 v138, 9, v138
    v_and_b32 v136, 4, v0
    v_add_u32 v136, v136, v142
    v_lshl_or_b32 v138, v136, 5, v138
    s_lshr_b32 s9, s99, 2
    s_lshl_b32 s9, s9, 11
    v_and_b32 v135, 31, v0
    v_lshlrev_b32 v135, 2, v135
    s_and_b32 s8, s2, 7
    s_lshl_b32 s8, s8, 7
    s_add_u32 s8, s8, 327680
    buffer_load_dword v204, v135, s[36:39], s8 offen sc1
    buffer_load_dwordx4 v[188:191], v138, s[36:39], s9 offen offset:0 sc1
    buffer_load_dwordx4 v[192:195], v138, s[36:39], s9 offen offset:16 sc1
    buffer_load_dwordx4 v[196:199], v138, s[36:39], s9 offen offset:256 sc1
    buffer_load_dwordx4 v[200:203], v138, s[36:39], s9 offen offset:272 sc1
    s_waitcnt vmcnt(10)
    buffer_load_dwordx4 a[212:215], v3, s[28:31], s72 offen offset:128 nt
    s_waitcnt vmcnt(10)
    buffer_load_dwordx4 a[216:219], v3, s[28:31], s72 offen offset:2048 nt
    s_cmp_lg_u32 s3, 0
    s_cbranch_scc1 L_ng0
    s_waitcnt lgkmcnt(0)
    s_cmp_eq_u32 s100, 0
    s_cselect_b32 s7, -3, 0
    s_cmp_eq_u32 s64, s6
    s_addc_u32 s7, s7, 0
    s_cmp_eq_u32 s65, s6
    s_addc_u32 s7, s7, 0
    s_cmp_eq_u32 s66, s6
    s_addc_u32 s7, s7, 0
    s_cmp_eq_u32 s67, s6
    s_addc_u32 s7, s7, 0
    s_cmp_eq_u32 s68, s6
    s_addc_u32 s7, s7, 0
    s_cmp_eq_u32 s69, s6
    s_addc_u32 s7, s7, 0
    s_cmp_eq_u32 s70, s6
    s_addc_u32 s7, s7, 0
    s_cmp_eq_u32 s71, s6
    s_addc_u32 s7, s7, 0
    s_cmp_lt_i32 s7, 4
    s_cselect_b32 s21, 1, 0
    v_mov_b32 v137, s21
    ds_write_b32 v243, v137
L_ng0:
    s_waitcnt vmcnt(10)
    buffer_load_dwordx4 a[220:223], v3, s[28:31], s72 offen offset:2176 nt
    s_add_u32 s72, s101, 786432
    s_waitcnt vmcnt(10)
    buffer_load_dwordx4 a[224:227], v2, s[28:31], s72 offen offset:0 nt
    ds_read_b32 v137, v243
    s_waitcnt vmcnt(10)
    buffer_load_dwordx4 a[228:231], v2, s[28:31], s72 offen offset:128 nt
    s_waitcnt lgkmcnt(0)
    v_readfirstlane_b32 s21, v137
    s_and_b32 s21, s21, 3
    s_cmp_lg_u32 s21, 0
    s_cselect_b64 vcc, -1, 0
    s_cbranch_vccnz L_s58
L_b58:
    s_waitcnt vmcnt(10)
    buffer_load_dwordx4 a[232:235], v2, s[28:31], s72 offen offset:2048 nt
    s_cbranch_vccnz L_s59
L_b59:
    s_waitcnt vmcnt(5)
    buffer_load_dwordx4 a[236:239], v2, s[28:31], s72 offen offset:2176 nt
L_qchk:
    v_max3_u32 v125, v189, v191, v193
    v_min3_u32 v126, v189, v191, v193
    v_max3_u32 v125, v125, v195, v197
    v_min3_u32 v126, v126, v195, v197
    v_max3_u32 v125, v125, v199, v201
    v_min3_u32 v126, v126, v199, v201
    v_max3_u32 v125, v125, v203, s6
    v_min3_u32 v126, v126, v203, s6
    v_cmp_ne_u32 vcc, v125, v126
    s_cbranch_vccnz L_qretry
L_qok:
    s_cmp_lg_u32 s21, 0
    s_cselect_b64 vcc, -1, 0
    v_cmp_ne_u32 s[0:1], s95, v204
    s_cmp_eq_u64 s[0:1], 0
    s_cselect_b32 s96, 1, 0
    v_cndmask_b32 v16, v188, 0, s[78:79]
    v_cndmask_b32 v20, 0, v188, s[78:79]
    v_cndmask_b32 v17, v190, 0, s[78:79]
    v_cndmask_b32 v21, 0, v190, s[78:79]
    v_cndmask_b32 v18, v192, 0, s[78:79]
    v_cndmask_b32 v22, 0, v192, s[78:79]
    v_cndmask_b32 v19, v194, 0, s[78:79]
    v_cndmask_b32 v23, 0, v194, s[78:79]
    v_cndmask_b32 v24, v196, 0, s[78:79]
    v_cndmask_b32 v28, 0, v196, s[78:79]
    v_cndmask_b32 v25, v198, 0, s[78:79]
    v_cndmask_b32 v29, 0, v198, s[78:79]
    v_cndmask_b32 v26, v200, 0, s[78:79]
    v_cndmask_b32 v30, 0, v200, s[78:79]
    v_cndmask_b32 v27, v202, 0, s[78:79]
    v_cndmask_b32 v31, 0, v202, s[78:79]
    v_mfma_f32_16x16x32_bf16 v[68:71], v[16:19], a[0:3], 0
    v_mfma_f32_16x16x32_bf16 v[68:71], v[24:27], a[4:7], v[68:71]
    v_mfma_f32_16x16x32_bf16 v[68:71], v[20:23], a[8:11], v[68:71]
    v_mfma_f32_16x16x32_bf16 v[68:71], v[28:31], a[12:15], v[68:71]
    s_add_u32 s72, s101, 802816
    s_cbranch_vccnz L_s60
L_b60:
    s_waitcnt vmcnt(5)
    buffer_load_dwordx4 a[240:243], v3, s[28:31], s72 offen offset:0 nt
    v_mfma_f32_16x16x32_bf16 v[72:75], v[16:19], a[16:19], 0
    v_mfma_f32_16x16x32_bf16 v[72:75], v[24:27], a[20:23], v[72:75]
    v_mfma_f32_16x16x32_bf16 v[72:75], v[20:23], a[24:27], v[72:75]
    v_mfma_f32_16x16x32_bf16 v[72:75], v[28:31], a[28:31], v[72:75]
    v_mfma_f32_16x16x32_bf16 v[76:79], v[16:19], a[32:35], 0
    v_mfma_f32_16x16x32_bf16 v[76:79], v[24:27], a[36:39], v[76:79]
    v_mfma_f32_16x16x32_bf16 v[76:79], v[20:23], a[40:43], v[76:79]
    v_mfma_f32_16x16x32_bf16 v[76:79], v[28:31], a[44:47], v[76:79]
    s_cbranch_vccnz L_s61
L_b61:
    s_waitcnt vmcnt(5)
    buffer_load_dwordx4 a[244:247], v3, s[28:31], s72 offen offset:128 nt
    s_lshr_b32 s7, s2, 3
    s_and_b32 s7, s7, 15
    s_cmp_lg_u32 s7, 5
    s_cbranch_scc1 L_nr1
    s_getpc_b64 s[0:1]
L_rp1:
    s_add_u32 s0, s0, 1536
    s_addc_u32 s1, s1, 0
    global_load_dwordx4 v[228:231], v255, s[0:1]
L_nr1:
    v_cndmask_b32 v125, v72, v68, s[76:77]
    v_cndmask_b32 v126, v73, v69, s[76:77]
    v_cndmask_b32 v127, v74, v70, s[76:77]
    v_cndmask_b32 v128, v75, v71, s[76:77]
    v_permlane16_swap_b32 v125, v126
    s_nop 0
    v_permlane16_swap_b32 v127, v128
    v_add_f32_dpp v125, v126, v125 quad_perm:[1,0,3,2] row_mask:0xf bank_mask:0xf
    s_nop 0
    v_add_f32_dpp v127, v128, v127 quad_perm:[1,0,3,2] row_mask:0xf bank_mask:0xf
    v_cvt_pk_bf16_f32 v125, v125, v127
    v_and_b32 v126, s5, v125
    v_lshlrev_b32 v125, 16, v125
    v_mul_f32 v126, s4, v126
    v_mul_f32 v125, s4, v125
    v_cvt_pk_bf16_f32 v125, v125, v126
    v_lshlrev_b32 v32, 16, v125
    v_and_b32 v33, s5, v125
    v_cndmask_b32 v32, v32, v252, s[24:25]
    v_cndmask_b32 v33, v33, v252, s[24:25]
    v_max_f32 v116, v116, v32
    v_max_f32 v117, v117, v33
    v_mfma_f32_16x16x32_bf16 v[80:83], v[16:19], a[48:51], 0
    v_mfma_f32_16x16x32_bf16 v[80:83], v[24:27], a[52:55], v[80:83]
    v_mfma_f32_16x16x32_bf16 v[80:83], v[20:23], a[56:59], v[80:83]
    v_mfma_f32_16x16x32_bf16 v[80:83], v[28:31], a[60:63], v[80:83]
    v_mfma_f32_16x16x32_bf16 v[68:71], v[16:19], a[64:67], 0
    v_mfma_f32_16x16x32_bf16 v[68:71], v[24:27], a[68:71], v[68:71]
    v_mfma_f32_16x16x32_bf16 v[68:71], v[20:23], a[72:75], v[68:71]
    s_cbranch_vccnz L_s62
L_b62:
    s_waitcnt vmcnt(5)
    buffer_load_dwordx4 a[248:251], v3, s[28:31], s72 offen offset:2048 nt
    s_cmp_lg_u32 s3, 1
    s_cbranch_scc1 L_np1
    s_and_b32 s7, s2, 7
    s_mul_i32 s8, s7, 8
    s_lshr_b32 s22, s2, 3
    s_add_u32 s22, s22, s8
    s_add_u32 s22, s22, 11
    s_and_b32 s0, s22, 31
    s_and_b32 s22, s22, 31
    s_lshl_b32 s22, s22, 7
    s_add_u32 s22, s22, 397312
    s_load_dwordx8 s[64:71], s[26:27], s22 glc
    s_lshl_b32 s7, s7, 2
    s_xor_b32 s22, s22, 2048
    s_add_u32 s22, s22, s7
    s_atomic_swap s6, s[26:27], s22
L_np1:
    v_mfma_f32_16x16x32_bf16 v[68:71], v[28:31], a[76:79], v[68:71]
    v_cndmask_b32 v125, v80, v76, s[76:77]
    v_cndmask_b32 v126, v81, v77, s[76:77]
    v_cndmask_b32 v127, v82, v78, s[76:77]
    v_cndmask_b32 v128, v83, v79, s[76:77]
    v_permlane16_swap_b32 v125, v126
    s_nop 0
    v_permlane16_swap_b32 v127, v128
    v_add_f32_dpp v125, v126, v125 quad_perm:[1,0,3,2] row_mask:0xf bank_mask:0xf
    s_nop 0
    v_add_f32_dpp v127, v128, v127 quad_perm:[1,0,3,2] row_mask:0xf bank_mask:0xf
    v_cvt_pk_bf16_f32 v125, v125, v127
    v_and_b32 v126, s5, v125
    v_lshlrev_b32 v125, 16, v125
    v_mul_f32 v126, s4, v126
    v_mul_f32 v125, s4, v125
    v_cvt_pk_bf16_f32 v125, v125, v126
    v_lshlrev_b32 v34, 16, v125
    v_and_b32 v35, s5, v125
    v_cndmask_b32 v34, v34, v252, s[24:25]
    v_cndmask_b32 v35, v35, v252, s[24:25]
    v_max_f32 v116, v116, v34
    v_max_f32 v117, v117, v35
    v_mfma_f32_16x16x32_bf16 v[72:75], v[16:19], a[80:83], 0
    v_mfma_f32_16x16x32_bf16 v[72:75], v[24:27], a[84:87], v[72:75]
    v_mfma_f32_16x16x32_bf16 v[72:75], v[20:23], a[88:91], v[72:75]
    v_mfma_f32_16x16x32_bf16 v[72:75], v[28:31], a[92:95], v[72:75]
    v_mfma_f32_16x16x32_bf16 v[76:79], v[16:19], a[96:99], 0
    v_mfma_f32_16x16x32_bf16 v[76:79], v[24:27], a[100:103], v[76:79]
    s_cbranch_vccnz L_s63
L_b63:
    s_waitcnt vmcnt(5)
    buffer_load_dwordx4 a[252:255], v3, s[28:31], s72 offen offset:2176 nt
    v_mfma_f32_16x16x32_bf16 v[76:79], v[20:23], a[104:107], v[76:79]
    v_mfma_f32_16x16x32_bf16 v[76:79], v[28:31], a[108:111], v[76:79]
    s_nop 1
    v_cndmask_b32 v125, v72, v68, s[76:77]
    v_cndmask_b32 v126, v73, v69, s[76:77]
    v_cndmask_b32 v127, v74, v70, s[76:77]
    v_cndmask_b32 v128, v75, v71, s[76:77]
    v_permlane16_swap_b32 v125, v126
    s_nop 0
    v_permlane16_swap_b32 v127, v128
    v_add_f32_dpp v125, v126, v125 quad_perm:[1,0,3,2] row_mask:0xf bank_mask:0xf
    s_nop 0
    v_add_f32_dpp v127, v128, v127 quad_perm:[1,0,3,2] row_mask:0xf bank_mask:0xf
    v_cvt_pk_bf16_f32 v125, v125, v127
    v_and_b32 v126, s5, v125
    v_lshlrev_b32 v125, 16, v125
    v_mul_f32 v126, s4, v126
    v_mul_f32 v125, s4, v125
    v_cvt_pk_bf16_f32 v125, v125, v126
    v_lshlrev_b32 v36, 16, v125
    v_and_b32 v37, s5, v125
    v_cndmask_b32 v36, v36, v252, s[24:25]
    v_cndmask_b32 v37, v37, v252, s[24:25]
    v_max_f32 v116, v116, v36
    v_max_f32 v117, v117, v37
    v_mfma_f32_16x16x32_bf16 v[80:83], v[16:19], a[112:115], 0
    v_mfma_f32_16x16x32_bf16 v[80:83], v[24:27], a[116:119], v[80:83]
    v_mfma_f32_16x16x32_bf16 v[80:83], v[20:23], a[120:123], v[80:83]
    v_mfma_f32_16x16x32_bf16 v[80:83], v[28:31], a[124:127], v[80:83]
    v_mfma_f32_16x16x32_bf16 v[68:71], v[16:19], a[128:131], 0
    s_add_u32 s72, s101, 917504
    s_cbranch_vccnz L_s64
L_b64:
    s_waitcnt vmcnt(5)
    buffer_load_dwordx4 a[0:3], v2, s[28:31], s72 offen offset:0 nt
    v_mfma_f32_16x16x32_bf16 v[68:71], v[24:27], a[132:135], v[68:71]
    v_mfma_f32_16x16x32_bf16 v[68:71], v[20:23], a[136:139], v[68:71]
    v_mfma_f32_16x16x32_bf16 v[68:71], v[28:31], a[140:143], v[68:71]
    s_nop 0
    v_cndmask_b32 v125, v80, v76, s[76:77]
    v_cndmask_b32 v126, v81, v77, s[76:77]
    v_cndmask_b32 v127, v82, v78, s[76:77]
    v_cndmask_b32 v128, v83, v79, s[76:77]
    v_permlane16_swap_b32 v125, v126
    s_nop 0
    v_permlane16_swap_b32 v127, v128
    v_add_f32_dpp v125, v126, v125 quad_perm:[1,0,3,2] row_mask:0xf bank_mask:0xf
    s_nop 0
    v_add_f32_dpp v127, v128, v127 quad_perm:[1,0,3,2] row_mask:0xf bank_mask:0xf
    v_cvt_pk_bf16_f32 v125, v125, v127
    v_and_b32 v126, s5, v125
    v_lshlrev_b32 v125, 16, v125
    v_mul_f32 v126, s4, v126
    v_mul_f32 v125, s4, v125
    v_cvt_pk_bf16_f32 v125, v125, v126
    v_lshlrev_b32 v38, 16, v125
    v_and_b32 v39, s5, v125
    v_cndmask_b32 v38, v38, v252, s[24:25]
    v_cndmask_b32 v39, v39, v252, s[24:25]
    v_max_f32 v116, v116, v38
    v_max_f32 v117, v117, v39
    v_mfma_f32_16x16x32_bf16 v[72:75], v[16:19], a[144:147], 0
    v_mfma_f32_16x16x32_bf16 v[72:75], v[24:27], a[148:151], v[72:75]
    v_mfma_f32_16x16x32_bf16 v[72:75], v[20:23], a[152:155], v[72:75]
    v_mfma_f32_16x16x32_bf16 v[72:75], v[28:31], a[156:159], v[72:75]
    s_cbranch_vccnz L_s65
L_b65:
    s_waitcnt vmcnt(5)
    buffer_load_dwordx4 a[4:7], v2, s[28:31], s72 offen offset:128 nt
    v_mfma_f32_16x16x32_bf16 v[76:79], v[16:19], a[160:163], 0
    v_mfma_f32_16x16x32_bf16 v[76:79], v[24:27], a[164:167], v[76:79]
    v_mfma_f32_16x16x32_bf16 v[76:79], v[20:23], a[168:171], v[76:79]
    v_mfma_f32_16x16x32_bf16 v[76:79], v[28:31], a[172:175], v[76:79]
    s_nop 1
    v_cndmask_b32 v125, v72, v68, s[76:77]
    v_cndmask_b32 v126, v73, v69, s[76:77]
    v_cndmask_b32 v127, v74, v70, s[76:77]
    v_cndmask_b32 v128, v75, v71, s[76:77]
    v_permlane16_swap_b32 v125, v126
    s_nop 0
    v_permlane16_swap_b32 v127, v128
    v_add_f32_dpp v125, v126, v125 quad_perm:[1,0,3,2] row_mask:0xf bank_mask:0xf
    s_nop 0
    v_add_f32_dpp v127, v128, v127 quad_perm:[1,0,3,2] row_mask:0xf bank_mask:0xf
    v_cvt_pk_bf16_f32 v125, v125, v127
    v_and_b32 v126, s5, v125
    v_lshlrev_b32 v125, 16, v125
    v_mul_f32 v126, s4, v126
    v_mul_f32 v125, s4, v125
    v_cvt_pk_bf16_f32 v125, v125, v126
    v_lshlrev_b32 v40, 16, v125
    v_and_b32 v41, s5, v125
    v_max_f32 v116, v116, v40
    v_max_f32 v117, v117, v41
    v_mfma_f32_16x16x32_bf16 v[80:83], v[16:19], a[176:179], 0
    v_mfma_f32_16x16x32_bf16 v[80:83], v[24:27], a[180:183], v[80:83]
    v_mfma_f32_16x16x32_bf16 v[80:83], v[20:23], a[184:187], v[80:83]
    s_cbranch_vccnz L_s66
L_b66:
    s_waitcnt vmcnt(5)
    buffer_load_dwordx4 a[8:11], v2, s[28:31], s72 offen offset:2048 nt
    v_mfma_f32_16x16x32_bf16 v[80:83], v[28:31], a[188:191], v[80:83]
    v_mfma_f32_16x16x32_bf16 v[68:71], v[16:19], a[192:195], 0
    v_mfma_f32_16x16x32_bf16 v[68:71], v[24:27], a[196:199], v[68:71]
    v_mfma_f32_16x16x32_bf16 v[68:71], v[20:23], a[200:203], v[68:71]
    v_mfma_f32_16x16x32_bf16 v[68:71], v[28:31], a[204:207], v[68:71]
    s_nop 3
    v_cndmask_b32 v125, v80, v76, s[76:77]
    v_cndmask_b32 v126, v81, v77, s[76:77]
    v_cndmask_b32 v127, v82, v78, s[76:77]
    v_cndmask_b32 v128, v83, v79, s[76:77]
    v_permlane16_swap_b32 v125, v126
    s_nop 0
    v_permlane16_swap_b32 v127, v128
    v_add_f32_dpp v125, v126, v125 quad_perm:[1,0,3,2] row_mask:0xf bank_mask:0xf
    s_nop 0
    v_add_f32_dpp v127, v128, v127 quad_perm:[1,0,3,2] row_mask:0xf bank_mask:0xf
    v_cvt_pk_bf16_f32 v125, v125, v127
    v_and_b32 v126, s5, v125
    v_lshlrev_b32 v125, 16, v125
    v_mul_f32 v126, s4, v126
    v_mul_f32 v125, s4, v125
    v_cvt_pk_bf16_f32 v125, v125, v126
    v_lshlrev_b32 v42, 16, v125
    v_and_b32 v43, s5, v125
    v_max_f32 v116, v116, v42
    v_max_f32 v117, v117, v43
    v_mfma_f32_16x16x32_bf16 v[72:75], v[16:19], a[208:211], 0
    v_mfma_f32_16x16x32_bf16 v[72:75], v[24:27], a[212:215], v[72:75]
    s_cbranch_vccnz L_s67
L_b67:
    s_waitcnt vmcnt(5)
    buffer_load_dwordx4 a[12:15], v2, s[28:31], s72 offen offset:2176 nt
    v_mfma_f32_16x16x32_bf16 v[72:75], v[20:23], a[216:219], v[72:75]
    v_mfma_f32_16x16x32_bf16 v[72:75], v[28:31], a[220:223], v[72:75]
    v_mfma_f32_16x16x32_bf16 v[76:79], v[16:19], a[224:227], 0
    v_mfma_f32_16x16x32_bf16 v[76:79], v[24:27], a[228:231], v[76:79]
    v_mfma_f32_16x16x32_bf16 v[76:79], v[20:23], a[232:235], v[76:79]
    v_mfma_f32_16x16x32_bf16 v[76:79], v[28:31], a[236:239], v[76:79]
    s_nop 3
    v_cndmask_b32 v125, v72, v68, s[76:77]
    v_cndmask_b32 v126, v73, v69, s[76:77]
    v_cndmask_b32 v127, v74, v70, s[76:77]
    v_cndmask_b32 v128, v75, v71, s[76:77]
    v_permlane16_swap_b32 v125, v126
    s_nop 0
    v_permlane16_swap_b32 v127, v128
    v_add_f32_dpp v125, v126, v125 quad_perm:[1,0,3,2] row_mask:0xf bank_mask:0xf
    s_nop 0
    v_add_f32_dpp v127, v128, v127 quad_perm:[1,0,3,2] row_mask:0xf bank_mask:0xf
    v_cvt_pk_bf16_f32 v125, v125, v127
    v_and_b32 v126, s5, v125
    v_lshlrev_b32 v125, 16, v125
    v_mul_f32 v126, s4, v126
    v_mul_f32 v125, s4, v125
    v_cvt_pk_bf16_f32 v125, v125, v126
    v_lshlrev_b32 v44, 16, v125
    v_and_b32 v45, s5, v125
    v_max_f32 v116, v116, v44
    v_max_f32 v117, v117, v45
    v_mfma_f32_16x16x32_bf16 v[80:83], v[16:19], a[240:243], 0
    s_add_u32 s72, s101, 933888
    s_cbranch_vccnz L_s68
L_b68:
    s_waitcnt vmcnt(5)
    buffer_load_dwordx4 a[16:19], v3, s[28:31], s72 offen offset:0 nt
    v_mfma_f32_16x16x32_bf16 v[80:83], v[24:27], a[244:247], v[80:83]
    v_mfma_f32_16x16x32_bf16 v[80:83], v[20:23], a[248:251], v[80:83]
    s_cbranch_vccnz L_s69
L_b69:
    s_waitcnt vmcnt(5)
    buffer_load_dwordx4 a[20:23], v3, s[28:31], s72 offen offset:128 nt
    v_mfma_f32_16x16x32_bf16 v[80:83], v[28:31], a[252:255], v[80:83]
    s_cbranch_vccnz L_s70
L_b70:
    s_waitcnt vmcnt(5)
    buffer_load_dwordx4 a[24:27], v3, s[28:31], s72 offen offset:2048 nt
    s_cmp_lg_u32 s3, 1
    s_cbranch_scc1 L_ng1
    s_waitcnt lgkmcnt(0)
    s_cmp_eq_u32 s100, 0
    s_cselect_b32 s7, -3, 0
    s_cmp_eq_u32 s64, s6
    s_addc_u32 s7, s7, 0
    s_cmp_eq_u32 s65, s6
    s_addc_u32 s7, s7, 0
    s_cmp_eq_u32 s66, s6
    s_addc_u32 s7, s7, 0
    s_cmp_eq_u32 s67, s6
    s_addc_u32 s7, s7, 0
    s_cmp_eq_u32 s68, s6
    s_addc_u32 s7, s7, 0
    s_cmp_eq_u32 s69, s6
    s_addc_u32 s7, s7, 0
    s_cmp_eq_u32 s70, s6
    s_addc_u32 s7, s7, 0
    s_cmp_eq_u32 s71, s6
    s_addc_u32 s7, s7, 0
    s_cmp_lt_i32 s7, 4
    s_cselect_b32 s21, 1, 0
    v_mov_b32 v137, s21
    ds_write_b32 v243, v137
L_ng1:
    v_mfma_f32_16x16x32_bf16 v[68:71], v[16:19], a[0:3], 0
    s_cbranch_vccnz L_s71
L_b71:
    s_waitcnt vmcnt(5)
    buffer_load_dwordx4 a[28:31], v3, s[28:31], s72 offen offset:2176 nt
    v_mfma_f32_16x16x32_bf16 v[68:71], v[24:27], a[4:7], v[68:71]
    s_add_u32 s72, s101, 1048576
    s_cbranch_vccnz L_s72
L_b72:
    s_waitcnt vmcnt(5)
    buffer_load_dwordx4 a[32:35], v2, s[28:31], s72 offen offset:0 nt
    ds_read_b32 v137, v243
    v_mfma_f32_16x16x32_bf16 v[68:71], v[20:23], a[8:11], v[68:71]
    s_cbranch_vccnz L_s73
L_b73:
    s_waitcnt vmcnt(5)
    buffer_load_dwordx4 a[36:39], v2, s[28:31], s72 offen offset:128 nt
    s_waitcnt lgkmcnt(0)
    v_readfirstlane_b32 s21, v137
    s_and_b32 s21, s21, 3
    s_cmp_lg_u32 s21, 0
    s_cselect_b64 vcc, -1, 0
    v_mfma_f32_16x16x32_bf16 v[68:71], v[28:31], a[12:15], v[68:71]
    v_cndmask_b32 v125, v80, v76, s[76:77]
    v_cndmask_b32 v126, v81, v77, s[76:77]
    v_cndmask_b32 v127, v82, v78, s[76:77]
    v_cndmask_b32 v128, v83, v79, s[76:77]
    v_permlane16_swap_b32 v125, v126
    s_nop 0
    v_permlane16_swap_b32 v127, v128
    v_add_f32_dpp v125, v126, v125 quad_perm:[1,0,3,2] row_mask:0xf bank_mask:0xf
    s_nop 0
    v_add_f32_dpp v127, v128, v127 quad_perm:[1,0,3,2] row_mask:0xf bank_mask:0xf
    v_cvt_pk_bf16_f32 v125, v125, v127
    v_and_b32 v126, s5, v125
    v_lshlrev_b32 v125, 16, v125
    v_mul_f32 v126, s4, v126
    v_mul_f32 v125, s4, v125
    v_cvt_pk_bf16_f32 v125, v125, v126
    v_lshlrev_b32 v46, 16, v125
    v_and_b32 v47, s5, v125
    v_max_f32 v116, v116, v46
    v_max_f32 v117, v117, v47
    s_cbranch_vccnz L_s74
L_b74:
    s_waitcnt vmcnt(5)
    buffer_load_dwordx4 a[40:43], v2, s[28:31], s72 offen offset:2048 nt
    v_mfma_f32_16x16x32_bf16 v[72:75], v[16:19], a[16:19], 0
    s_cbranch_vccnz L_s75
L_b75:
    s_waitcnt vmcnt(5)
    buffer_load_dwordx4 a[44:47], v2, s[28:31], s72 offen offset:2176 nt
    v_mfma_f32_16x16x32_bf16 v[72:75], v[24:27], a[20:23], v[72:75]
    s_add_u32 s72, s101, 1064960
    s_cbranch_vccnz L_s76
L_b76:
    s_waitcnt vmcnt(5)
    buffer_load_dwordx4 a[48:51], v3, s[28:31], s72 offen offset:0 nt
    v_mfma_f32_16x16x32_bf16 v[72:75], v[20:23], a[24:27], v[72:75]
    s_cbranch_vccnz L_s77
L_b77:
    s_waitcnt vmcnt(5)
    buffer_load_dwordx4 a[52:55], v3, s[28:31], s72 offen offset:128 nt
    v_mfma_f32_16x16x32_bf16 v[72:75], v[28:31], a[28:31], v[72:75]
    s_cbranch_vccnz L_s78
L_b78:
    s_waitcnt vmcnt(5)
    buffer_load_dwordx4 a[56:59], v3, s[28:31], s72 offen offset:2048 nt
    s_cmp_lg_u32 s3, 2
    s_cbranch_scc1 L_np2
    s_and_b32 s7, s2, 7
    s_mul_i32 s8, s7, 11
    s_lshr_b32 s22, s2, 3
    s_add_u32 s22, s22, s8
    s_add_u32 s22, s22, 22
    s_and_b32 s0, s22, 31
    s_and_b32 s22, s22, 31
    s_lshl_b32 s22, s22, 7
    s_add_u32 s22, s22, 401408
    s_load_dwordx8 s[64:71], s[26:27], s22 glc
    s_lshl_b32 s7, s7, 2
    s_xor_b32 s22, s22, 2048
    s_add_u32 s22, s22, s7
    s_atomic_swap s6, s[26:27], s22
L_np2:
    v_mfma_f32_16x16x32_bf16 v[76:79], v[16:19], a[32:35], 0
    s_cbranch_vccnz L_s79
L_b79:
    s_waitcnt vmcnt(5)
    buffer_load_dwordx4 a[60:63], v3, s[28:31], s72 offen offset:2176 nt
    v_mfma_f32_16x16x32_bf16 v[76:79], v[24:27], a[36:39], v[76:79]
    s_add_u32 s72, s101, 1179648
    s_cbranch_vccnz L_s80
L_b80:
    s_waitcnt vmcnt(5)
    buffer_load_dwordx4 a[64:67], v2, s[28:31], s72 offen offset:0 nt
    v_mfma_f32_16x16x32_bf16 v[76:79], v[20:23], a[40:43], v[76:79]
    s_cbranch_vccnz L_s81
L_b81:
    s_waitcnt vmcnt(5)
    buffer_load_dwordx4 a[68:71], v2, s[28:31], s72 offen offset:128 nt
    v_mfma_f32_16x16x32_bf16 v[76:79], v[28:31], a[44:47], v[76:79]
    v_cndmask_b32 v125, v72, v68, s[76:77]
    v_cndmask_b32 v126, v73, v69, s[76:77]
    v_cndmask_b32 v127, v74, v70, s[76:77]
    v_cndmask_b32 v128, v75, v71, s[76:77]
    v_permlane16_swap_b32 v125, v126
    s_nop 0
    v_permlane16_swap_b32 v127, v128
    v_add_f32_dpp v125, v126, v125 quad_perm:[1,0,3,2] row_mask:0xf bank_mask:0xf
    s_nop 0
    v_add_f32_dpp v127, v128, v127 quad_perm:[1,0,3,2] row_mask:0xf bank_mask:0xf
    v_cvt_pk_bf16_f32 v125, v125, v127
    v_and_b32 v126, s5, v125
    v_lshlrev_b32 v125, 16, v125
    v_mul_f32 v126, s4, v126
    v_mul_f32 v125, s4, v125
    v_cvt_pk_bf16_f32 v125, v125, v126
    v_lshlrev_b32 v48, 16, v125
    v_and_b32 v49, s5, v125
    v_max_f32 v116, v116, v48
    v_max_f32 v117, v117, v49
    s_cbranch_vccnz L_s82
L_b82:
    s_waitcnt vmcnt(5)
    buffer_load_dwordx4 a[72:75], v2, s[28:31], s72 offen offset:2048 nt
    v_mfma_f32_16x16x32_bf16 v[80:83], v[16:19], a[48:51], 0
    s_cbranch_vccnz L_s83
L_b83:
    s_waitcnt vmcnt(5)
    buffer_load_dwordx4 a[76:79], v2, s[28:31], s72 offen offset:2176 nt
    v_mfma_f32_16x16x32_bf16 v[80:83], v[24:27], a[52:55], v[80:83]
    s_add_u32 s72, s101, 1196032
    s_cbranch_vccnz L_s84
L_b84:
    s_waitcnt vmcnt(5)
    buffer_load_dwordx4 a[80:83], v3, s[28:31], s72 offen offset:0 nt
    v_mfma_f32_16x16x32_bf16 v[80:83], v[20:23], a[56:59], v[80:83]
    s_cbranch_vccnz L_s85
L_b85:
    s_waitcnt vmcnt(5)
    buffer_load_dwordx4 a[84:87], v3, s[28:31], s72 offen offset:128 nt
    v_mfma_f32_16x16x32_bf16 v[80:83], v[28:31], a[60:63], v[80:83]
    s_cbranch_vccnz L_s86
L_b86:
    s_waitcnt vmcnt(5)
    buffer_load_dwordx4 a[88:91], v3, s[28:31], s72 offen offset:2048 nt
    s_cmp_lg_u32 s3, 2
    s_cbranch_scc1 L_ng2
    s_waitcnt lgkmcnt(0)
    s_cmp_eq_u32 s100, 0
    s_cselect_b32 s7, -3, 0
    s_cmp_eq_u32 s64, s6
    s_addc_u32 s7, s7, 0
    s_cmp_eq_u32 s65, s6
    s_addc_u32 s7, s7, 0
    s_cmp_eq_u32 s66, s6
    s_addc_u32 s7, s7, 0
    s_cmp_eq_u32 s67, s6
    s_addc_u32 s7, s7, 0
    s_cmp_eq_u32 s68, s6
    s_addc_u32 s7, s7, 0
    s_cmp_eq_u32 s69, s6
    s_addc_u32 s7, s7, 0
    s_cmp_eq_u32 s70, s6
    s_addc_u32 s7, s7, 0
    s_cmp_eq_u32 s71, s6
    s_addc_u32 s7, s7, 0
    s_cmp_lt_i32 s7, 4
    s_cselect_b32 s21, 1, 0
    v_mov_b32 v137, s21
    ds_write_b32 v243, v137
L_ng2:
    v_mfma_f32_16x16x32_bf16 v[68:71], v[16:19], a[64:67], 0
    s_cbranch_vccnz L_s87
L_b87:
    s_waitcnt vmcnt(5)
    buffer_load_dwordx4 a[92:95], v3, s[28:31], s72 offen offset:2176 nt
    v_mfma_f32_16x16x32_bf16 v[68:71], v[24:27], a[68:71], v[68:71]
    s_add_u32 s72, s101, 1310720
    s_cbranch_vccnz L_s88
L_b88:
    s_waitcnt vmcnt(5)
    buffer_load_dwordx4 a[96:99], v2, s[28:31], s72 offen offset:0 nt
    ds_read_b32 v137, v243
    v_mfma_f32_16x16x32_bf16 v[68:71], v[20:23], a[72:75], v[68:71]
    s_cbranch_vccnz L_s89
L_b89:
    s_waitcnt vmcnt(5)
    buffer_load_dwordx4 a[100:103], v2, s[28:31], s72 offen offset:128 nt
    s_lshr_b32 s7, s2, 3
    s_and_b32 s7, s7, 15
    s_cmp_lg_u32 s7, 10
    s_cbranch_scc1 L_nr2
    s_getpc_b64 s[0:1]
L_rp2:
    s_add_u32 s0, s0, 1536
    s_addc_u32 s1, s1, 0
    global_load_dwordx4 v[228:231], v255, s[0:1]
L_nr2:
    s_waitcnt lgkmcnt(0)
    v_readfirstlane_b32 s21, v137
    s_and_b32 s21, s21, 3
    s_cmp_lg_u32 s21, 0
    s_cselect_b64 vcc, -1, 0
    v_mfma_f32_16x16x32_bf16 v[68:71], v[28:31], a[76:79], v[68:71]
    v_cndmask_b32 v125, v80, v76, s[76:77]
    v_cndmask_b32 v126, v81, v77, s[76:77]
    v_cndmask_b32 v127, v82, v78, s[76:77]
    v_cndmask_b32 v128, v83, v79, s[76:77]
    v_permlane16_swap_b32 v125, v126
    s_nop 0
    v_permlane16_swap_b32 v127, v128
    v_add_f32_dpp v125, v126, v125 quad_perm:[1,0,3,2] row_mask:0xf bank_mask:0xf
    s_nop 0
    v_add_f32_dpp v127, v128, v127 quad_perm:[1,0,3,2] row_mask:0xf bank_mask:0xf
    v_cvt_pk_bf16_f32 v125, v125, v127
    v_and_b32 v126, s5, v125
    v_lshlrev_b32 v125, 16, v125
    v_mul_f32 v126, s4, v126
    v_mul_f32 v125, s4, v125
    v_cvt_pk_bf16_f32 v125, v125, v126
    v_lshlrev_b32 v50, 16, v125
    v_and_b32 v51, s5, v125
    v_max_f32 v116, v116, v50
    v_max_f32 v117, v117, v51
    s_cbranch_vccnz L_s90
L_b90:
    s_waitcnt vmcnt(5)
    buffer_load_dwordx4 a[104:107], v2, s[28:31], s72 offen offset:2048 nt
    v_mfma_f32_16x16x32_bf16 v[72:75], v[16:19], a[80:83], 0
    s_cbranch_vccnz L_s91
L_b91:
    s_waitcnt vmcnt(5)
    buffer_load_dwordx4 a[108:111], v2, s[28:31], s72 offen offset:2176 nt
    v_mfma_f32_16x16x32_bf16 v[72:75], v[24:27], a[84:87], v[72:75]
    s_add_u32 s72, s101, 1327104
    s_cbranch_vccnz L_s92
L_b92:
    s_waitcnt vmcnt(5)
    buffer_load_dwordx4 a[112:115], v3, s[28:31], s72 offen offset:0 nt
    v_mfma_f32_16x16x32_bf16 v[72:75], v[20:23], a[88:91], v[72:75]
    s_cbranch_vccnz L_s93
L_b93:
    s_waitcnt vmcnt(5)
    buffer_load_dwordx4 a[116:119], v3, s[28:31], s72 offen offset:128 nt
    v_mfma_f32_16x16x32_bf16 v[72:75], v[28:31], a[92:95], v[72:75]
    s_cbranch_vccnz L_s94
L_b94:
    s_waitcnt vmcnt(5)
    buffer_load_dwordx4 a[120:123], v3, s[28:31], s72 offen offset:2048 nt
    s_cmp_lg_u32 s3, 3
    s_cbranch_scc1 L_np3
    s_and_b32 s7, s2, 7
    s_mul_i32 s8, s7, 14
    s_lshr_b32 s22, s2, 3
    s_add_u32 s22, s22, s8
    s_add_u32 s22, s22, 1
    s_and_b32 s0, s22, 31
    s_and_b32 s22, s22, 31
    s_lshl_b32 s22, s22, 7
    s_add_u32 s22, s22, 405504
    s_load_dwordx8 s[64:71], s[26:27], s22 glc
    s_lshl_b32 s7, s7, 2
    s_xor_b32 s22, s22, 2048
    s_add_u32 s22, s22, s7
    s_atomic_swap s6, s[26:27], s22
L_np3:
    v_mfma_f32_16x16x32_bf16 v[76:79], v[16:19], a[96:99], 0
    s_cbranch_vccnz L_s95
L_b95:
    s_waitcnt vmcnt(5)
    buffer_load_dwordx4 a[124:127], v3, s[28:31], s72 offen offset:2176 nt
    v_mfma_f32_16x16x32_bf16 v[76:79], v[24:27], a[100:103], v[76:79]
    s_add_u32 s72, s101, 1441792
    s_cbranch_vccnz L_s96
L_b96:
    s_waitcnt vmcnt(5)
    buffer_load_dwordx4 a[128:131], v2, s[28:31], s72 offen offset:0 nt
    v_mfma_f32_16x16x32_bf16 v[76:79], v[20:23], a[104:107], v[76:79]
    s_cbranch_vccnz L_s97
L_b97:
    s_waitcnt vmcnt(5)
    buffer_load_dwordx4 a[132:135], v2, s[28:31], s72 offen offset:128 nt
    v_mfma_f32_16x16x32_bf16 v[76:79], v[28:31], a[108:111], v[76:79]
    v_cndmask_b32 v125, v72, v68, s[76:77]
    v_cndmask_b32 v126, v73, v69, s[76:77]
    v_cndmask_b32 v127, v74, v70, s[76:77]
    v_cndmask_b32 v128, v75, v71, s[76:77]
    v_permlane16_swap_b32 v125, v126
    s_nop 0
    v_permlane16_swap_b32 v127, v128
    v_add_f32_dpp v125, v126, v125 quad_perm:[1,0,3,2] row_mask:0xf bank_mask:0xf
    s_nop 0
    v_add_f32_dpp v127, v128, v127 quad_perm:[1,0,3,2] row_mask:0xf bank_mask:0xf
    v_cvt_pk_bf16_f32 v125, v125, v127
    v_and_b32 v126, s5, v125
    v_lshlrev_b32 v125, 16, v125
    v_mul_f32 v126, s4, v126
    v_mul_f32 v125, s4, v125
    v_cvt_pk_bf16_f32 v125, v125, v126
    v_lshlrev_b32 v52, 16, v125
    v_and_b32 v53, s5, v125
    v_max_f32 v116, v116, v52
    v_max_f32 v117, v117, v53
    s_cbranch_vccnz L_s98
L_b98:
    s_waitcnt vmcnt(5)
    buffer_load_dwordx4 a[136:139], v2, s[28:31], s72 offen offset:2048 nt
    v_mfma_f32_16x16x32_bf16 v[80:83], v[16:19], a[112:115], 0
    s_cbranch_vccnz L_s99
L_b99:
    s_waitcnt vmcnt(5)
    buffer_load_dwordx4 a[140:143], v2, s[28:31], s72 offen offset:2176 nt
    v_and_b32 v135, 7, v0
    v_lshlrev_b32 v135, 10, v135
    v_bfe_u32 v136, v0, 3, 1
    v_lshl_or_b32 v135, v136, 1, v135
    v_bfe_u32 v136, v0, 5, 1
    v_lshl_or_b32 v135, v136, 2, v135
    v_bfe_u32 v136, v0, 4, 1
    v_lshl_or_b32 v135, v136, 3, v135
    s_lshr_b32 s7, s2, 5
    s_lshl_b32 s7, s7, 3
    s_and_b32 s0, s100, 2
    s_lshl_b32 s0, s0, 1
    s_add_u32 s7, s7, s0
    s_add_u32 s7, s7, s3
    s_lshl_b32 s7, s7, 4
    buffer_load_ushort v124, v135, s[40:43], s7 offen
    v_mfma_f32_16x16x32_bf16 v[80:83], v[24:27], a[116:119], v[80:83]
    s_add_u32 s72, s101, 1458176
    s_cbranch_vccnz L_s100
L_b100:
    s_waitcnt vmcnt(6)
    buffer_load_dwordx4 a[144:147], v3, s[28:31], s72 offen offset:0 nt
    v_mfma_f32_16x16x32_bf16 v[80:83], v[20:23], a[120:123], v[80:83]
    s_cbranch_vccnz L_s101
L_b101:
    s_waitcnt vmcnt(6)
    buffer_load_dwordx4 a[148:151], v3, s[28:31], s72 offen offset:128 nt
    v_mfma_f32_16x16x32_bf16 v[80:83], v[28:31], a[124:127], v[80:83]
    s_cbranch_vccnz L_s102
L_b102:
    s_waitcnt vmcnt(6)
    buffer_load_dwordx4 a[152:155], v3, s[28:31], s72 offen offset:2048 nt
    s_cmp_lg_u32 s3, 3
    s_cbranch_scc1 L_ng3
    s_waitcnt lgkmcnt(0)
    s_cmp_eq_u32 s100, 0
    s_cselect_b32 s7, -3, 0
    s_cmp_eq_u32 s64, s6
    s_addc_u32 s7, s7, 0
    s_cmp_eq_u32 s65, s6
    s_addc_u32 s7, s7, 0
    s_cmp_eq_u32 s66, s6
    s_addc_u32 s7, s7, 0
    s_cmp_eq_u32 s67, s6
    s_addc_u32 s7, s7, 0
    s_cmp_eq_u32 s68, s6
    s_addc_u32 s7, s7, 0
    s_cmp_eq_u32 s69, s6
    s_addc_u32 s7, s7, 0
    s_cmp_eq_u32 s70, s6
    s_addc_u32 s7, s7, 0
    s_cmp_eq_u32 s71, s6
    s_addc_u32 s7, s7, 0
    s_cmp_lt_i32 s7, 4
    s_cselect_b32 s21, 1, 0
    v_mov_b32 v137, s21
    ds_write_b32 v243, v137
L_ng3:
    v_mfma_f32_16x16x32_bf16 v[68:71], v[16:19], a[128:131], 0
    s_cbranch_vccnz L_s103
L_b103:
    s_waitcnt vmcnt(6)
    buffer_load_dwordx4 a[156:159], v3, s[28:31], s72 offen offset:2176 nt
    v_mfma_f32_16x16x32_bf16 v[68:71], v[24:27], a[132:135], v[68:71]
    s_add_u32 s72, s101, 1572864
    s_cbranch_vccnz L_s104
L_b104:
    s_waitcnt vmcnt(6)
    buffer_load_dwordx4 a[160:163], v2, s[28:31], s72 offen offset:0 nt
    ds_read_b32 v137, v243
    v_mfma_f32_16x16x32_bf16 v[68:71], v[20:23], a[136:139], v[68:71]
    s_cbranch_vccnz L_s105
L_b105:
    s_waitcnt vmcnt(6)
    buffer_load_dwordx4 a[164:167], v2, s[28:31], s72 offen offset:128 nt
    s_waitcnt lgkmcnt(0)
    v_readfirstlane_b32 s21, v137
    s_and_b32 s21, s21, 3
    s_cmp_lg_u32 s21, 0
    s_cselect_b64 vcc, -1, 0
    v_mfma_f32_16x16x32_bf16 v[68:71], v[28:31], a[140:143], v[68:71]
    v_cndmask_b32 v125, v80, v76, s[76:77]
    v_cndmask_b32 v126, v81, v77, s[76:77]
    v_cndmask_b32 v127, v82, v78, s[76:77]
    v_cndmask_b32 v128, v83, v79, s[76:77]
    v_permlane16_swap_b32 v125, v126
    s_nop 0
    v_permlane16_swap_b32 v127, v128
    v_add_f32_dpp v125, v126, v125 quad_perm:[1,0,3,2] row_mask:0xf bank_mask:0xf
    s_nop 0
    v_add_f32_dpp v127, v128, v127 quad_perm:[1,0,3,2] row_mask:0xf bank_mask:0xf
    v_cvt_pk_bf16_f32 v125, v125, v127
    v_and_b32 v126, s5, v125
    v_lshlrev_b32 v125, 16, v125
    v_mul_f32 v126, s4, v126
    v_mul_f32 v125, s4, v125
    v_cvt_pk_bf16_f32 v125, v125, v126
    v_lshlrev_b32 v54, 16, v125
    v_and_b32 v55, s5, v125
    v_max_f32 v116, v116, v54
    v_max_f32 v117, v117, v55
    s_cbranch_vccnz L_s106
L_b106:
    s_waitcnt vmcnt(5)
    buffer_load_dwordx4 a[168:171], v2, s[28:31], s72 offen offset:2048 nt
    v_mfma_f32_16x16x32_bf16 v[72:75], v[16:19], a[144:147], 0
    s_cbranch_vccnz L_s107
L_b107:
    s_waitcnt vmcnt(5)
    buffer_load_dwordx4 a[172:175], v2, s[28:31], s72 offen offset:2176 nt
    v_mfma_f32_16x16x32_bf16 v[72:75], v[24:27], a[148:151], v[72:75]
    s_add_u32 s72, s101, 1589248
    s_cbranch_vccnz L_s108
L_b108:
    s_waitcnt vmcnt(5)
    buffer_load_dwordx4 a[176:179], v3, s[28:31], s72 offen offset:0 nt
    v_mfma_f32_16x16x32_bf16 v[72:75], v[20:23], a[152:155], v[72:75]
    s_cbranch_vccnz L_s109
L_b109:
    s_waitcnt vmcnt(5)
    buffer_load_dwordx4 a[180:183], v3, s[28:31], s72 offen offset:128 nt
    v_mfma_f32_16x16x32_bf16 v[72:75], v[28:31], a[156:159], v[72:75]
    s_cbranch_vccnz L_s110
L_b110:
    s_waitcnt vmcnt(5)
    buffer_load_dwordx4 a[184:187], v3, s[28:31], s72 offen offset:2048 nt
    s_cmp_lg_u32 s3, 0
    s_cbranch_scc1 L_np4
    s_and_b32 s7, s2, 7
    s_mul_i32 s8, s7, 17
    s_lshr_b32 s22, s2, 3
    s_add_u32 s22, s22, s8
    s_add_u32 s22, s22, 12
    s_and_b32 s0, s22, 31
    s_and_b32 s22, s22, 31
    s_lshl_b32 s22, s22, 7
    s_add_u32 s22, s22, 409600
    s_load_dwordx8 s[64:71], s[26:27], s22 glc
    s_lshl_b32 s7, s7, 2
    s_xor_b32 s22, s22, 2048
    s_add_u32 s22, s22, s7
    s_atomic_swap s6, s[26:27], s22
L_np4:
    v_mfma_f32_16x16x32_bf16 v[76:79], v[16:19], a[160:163], 0
    s_cbranch_vccnz L_s111
L_b111:
    s_waitcnt vmcnt(5)
    buffer_load_dwordx4 a[188:191], v3, s[28:31], s72 offen offset:2176 nt
    v_mfma_f32_16x16x32_bf16 v[76:79], v[24:27], a[164:167], v[76:79]
    s_add_u32 s72, s101, 1703936
    s_cbranch_vccnz L_s112
L_b112:
    s_waitcnt vmcnt(5)
    buffer_load_dwordx4 a[192:195], v2, s[28:31], s72 offen offset:0 nt
    v_mfma_f32_16x16x32_bf16 v[76:79], v[20:23], a[168:171], v[76:79]
    s_cbranch_vccnz L_s113
L_b113:
    s_waitcnt vmcnt(5)
    buffer_load_dwordx4 a[196:199], v2, s[28:31], s72 offen offset:128 nt
    v_mfma_f32_16x16x32_bf16 v[76:79], v[28:31], a[172:175], v[76:79]
    v_cndmask_b32 v125, v72, v68, s[76:77]
    v_cndmask_b32 v126, v73, v69, s[76:77]
    v_cndmask_b32 v127, v74, v70, s[76:77]
    v_cndmask_b32 v128, v75, v71, s[76:77]
    v_permlane16_swap_b32 v125, v126
    s_nop 0
    v_permlane16_swap_b32 v127, v128
    v_add_f32_dpp v125, v126, v125 quad_perm:[1,0,3,2] row_mask:0xf bank_mask:0xf
    s_nop 0
    v_add_f32_dpp v127, v128, v127 quad_perm:[1,0,3,2] row_mask:0xf bank_mask:0xf
    v_cvt_pk_bf16_f32 v125, v125, v127
    v_and_b32 v126, s5, v125
    v_lshlrev_b32 v125, 16, v125
    v_mul_f32 v126, s4, v126
    v_mul_f32 v125, s4, v125
    v_cvt_pk_bf16_f32 v125, v125, v126
    v_lshlrev_b32 v56, 16, v125
    v_and_b32 v57, s5, v125
    v_max_f32 v116, v116, v56
    v_max_f32 v117, v117, v57
    s_cbranch_vccnz L_s114
L_b114:
    s_waitcnt vmcnt(5)
    buffer_load_dwordx4 a[200:203], v2, s[28:31], s72 offen offset:2048 nt
    v_mfma_f32_16x16x32_bf16 v[80:83], v[16:19], a[176:179], 0
    s_cbranch_vccnz L_s115
L_b115:
    s_waitcnt vmcnt(5)
    buffer_load_dwordx4 a[204:207], v2, s[28:31], s72 offen offset:2176 nt
    v_mfma_f32_16x16x32_bf16 v[80:83], v[24:27], a[180:183], v[80:83]
    s_add_u32 s72, s101, 1720320
    s_cbranch_vccnz L_s116
L_b116:
    s_waitcnt vmcnt(5)
    buffer_load_dwordx4 a[208:211], v3, s[28:31], s72 offen offset:0 nt
    v_mfma_f32_16x16x32_bf16 v[80:83], v[20:23], a[184:187], v[80:83]
    s_cbranch_vccnz L_s117
L_b117:
    s_waitcnt vmcnt(5)
    buffer_load_dwordx4 a[212:215], v3, s[28:31], s72 offen offset:128 nt
    s_lshr_b32 s7, s2, 3
    s_and_b32 s7, s7, 15
    s_cmp_lg_u32 s7, 15
    s_cbranch_scc1 L_nr3
    s_getpc_b64 s[0:1]
L_rp3:
    s_add_u32 s0, s0, 1536
    s_addc_u32 s1, s1, 0
    global_load_dwordx4 v[228:231], v255, s[0:1]
L_nr3:
    v_mfma_f32_16x16x32_bf16 v[80:83], v[28:31], a[188:191], v[80:83]
    s_cbranch_vccnz L_s118
L_b118:
    s_waitcnt vmcnt(5)
    buffer_load_dwordx4 a[216:219], v3, s[28:31], s72 offen offset:2048 nt
    s_cmp_lg_u32 s3, 0
    s_cbranch_scc1 L_ng4
    s_waitcnt lgkmcnt(0)
    s_cmp_eq_u32 s100, 0
    s_cselect_b32 s7, -3, 0
    s_cmp_eq_u32 s64, s6
    s_addc_u32 s7, s7, 0
    s_cmp_eq_u32 s65, s6
    s_addc_u32 s7, s7, 0
    s_cmp_eq_u32 s66, s6
    s_addc_u32 s7, s7, 0
    s_cmp_eq_u32 s67, s6
    s_addc_u32 s7, s7, 0
    s_cmp_eq_u32 s68, s6
    s_addc_u32 s7, s7, 0
    s_cmp_eq_u32 s69, s6
    s_addc_u32 s7, s7, 0
    s_cmp_eq_u32 s70, s6
    s_addc_u32 s7, s7, 0
    s_cmp_eq_u32 s71, s6
    s_addc_u32 s7, s7, 0
    s_cmp_lt_i32 s7, 4
    s_cselect_b32 s21, 1, 0
    v_mov_b32 v137, s21
    ds_write_b32 v243, v137
L_ng4:
    v_mfma_f32_16x16x32_bf16 v[68:71], v[16:19], a[192:195], 0
    s_cbranch_vccnz L_s119
L_b119:
    s_waitcnt vmcnt(5)
    buffer_load_dwordx4 a[220:223], v3, s[28:31], s72 offen offset:2176 nt
    v_mfma_f32_16x16x32_bf16 v[68:71], v[24:27], a[196:199], v[68:71]
    s_add_u32 s72, s101, 1835008
    s_cbranch_vccnz L_s120
L_b120:
    s_waitcnt vmcnt(5)
    buffer_load_dwordx4 a[224:227], v2, s[28:31], s72 offen offset:0 nt
    ds_read_b32 v137, v243
    v_mfma_f32_16x16x32_bf16 v[68:71], v[20:23], a[200:203], v[68:71]
    s_cbranch_vccnz L_s121
L_b121:
    s_waitcnt vmcnt(5)
    buffer_load_dwordx4 a[228:231], v2, s[28:31], s72 offen offset:128 nt
    s_waitcnt lgkmcnt(0)
    v_readfirstlane_b32 s21, v137
    s_and_b32 s21, s21, 3
    s_cmp_lg_u32 s21, 0
    s_cselect_b64 vcc, -1, 0
    v_mfma_f32_16x16x32_bf16 v[68:71], v[28:31], a[204:207], v[68:71]
    v_cndmask_b32 v125, v80, v76, s[76:77]
    v_cndmask_b32 v126, v81, v77, s[76:77]
    v_cndmask_b32 v127, v82, v78, s[76:77]
    v_cndmask_b32 v128, v83, v79, s[76:77]
    v_permlane16_swap_b32 v125, v126
    s_nop 0
    v_permlane16_swap_b32 v127, v128
    v_add_f32_dpp v125, v126, v125 quad_perm:[1,0,3,2] row_mask:0xf bank_mask:0xf
    s_nop 0
    v_add_f32_dpp v127, v128, v127 quad_perm:[1,0,3,2] row_mask:0xf bank_mask:0xf
    v_cvt_pk_bf16_f32 v125, v125, v127
    v_and_b32 v126, s5, v125
    v_lshlrev_b32 v125, 16, v125
    v_mul_f32 v126, s4, v126
    v_mul_f32 v125, s4, v125
    v_cvt_pk_bf16_f32 v125, v125, v126
    v_lshlrev_b32 v58, 16, v125
    v_and_b32 v59, s5, v125
    v_max_f32 v116, v116, v58
    v_max_f32 v117, v117, v59
    s_cbranch_vccnz L_s122
L_b122:
    s_waitcnt vmcnt(5)
    buffer_load_dwordx4 a[232:235], v2, s[28:31], s72 offen offset:2048 nt
    v_mfma_f32_16x16x32_bf16 v[72:75], v[16:19], a[208:211], 0
    s_cbranch_vccnz L_s123
L_b123:
    s_waitcnt vmcnt(5)
    buffer_load_dwordx4 a[236:239], v2, s[28:31], s72 offen offset:2176 nt
    v_mfma_f32_16x16x32_bf16 v[72:75], v[24:27], a[212:215], v[72:75]
    s_add_u32 s72, s101, 1851392
    s_cbranch_vccnz L_s124
L_b124:
    s_waitcnt vmcnt(5)
    buffer_load_dwordx4 a[240:243], v3, s[28:31], s72 offen offset:0 nt
    v_mfma_f32_16x16x32_bf16 v[72:75], v[20:23], a[216:219], v[72:75]
    s_cbranch_vccnz L_s125
L_b125:
    s_waitcnt vmcnt(5)
    buffer_load_dwordx4 a[244:247], v3, s[28:31], s72 offen offset:128 nt
    v_mfma_f32_16x16x32_bf16 v[72:75], v[28:31], a[220:223], v[72:75]
    s_cbranch_vccnz L_s126
L_b126:
    s_waitcnt vmcnt(5)
    buffer_load_dwordx4 a[248:251], v3, s[28:31], s72 offen offset:2048 nt
    s_cmp_lg_u32 s3, 1
    s_cbranch_scc1 L_np5
    s_and_b32 s7, s2, 7
    s_mul_i32 s8, s7, 20
    s_lshr_b32 s22, s2, 3
    s_add_u32 s22, s22, s8
    s_add_u32 s22, s22, 23
    s_and_b32 s0, s22, 31
    s_and_b32 s22, s22, 31
    s_lshl_b32 s22, s22, 7
    s_add_u32 s22, s22, 413696
    s_load_dwordx8 s[64:71], s[26:27], s22 glc
    s_lshl_b32 s7, s7, 2
    s_xor_b32 s22, s22, 2048
    s_add_u32 s22, s22, s7
    s_atomic_swap s6, s[26:27], s22
L_np5:
    v_mfma_f32_16x16x32_bf16 v[76:79], v[16:19], a[224:227], 0
    s_cbranch_vccnz L_s127
L_b127:
    s_waitcnt vmcnt(5)
    buffer_load_dwordx4 a[252:255], v3, s[28:31], s72 offen offset:2176 nt
    v_mfma_f32_16x16x32_bf16 v[76:79], v[24:27], a[228:231], v[76:79]
    s_add_u32 s72, s101, 1966080
    s_cbranch_vccnz L_s128
L_b128:
    s_waitcnt vmcnt(5)
    buffer_load_dwordx4 a[0:3], v2, s[28:31], s72 offen offset:0 nt
    v_mfma_f32_16x16x32_bf16 v[76:79], v[20:23], a[232:235], v[76:79]
    s_cbranch_vccnz L_s129
L_b129:
    s_waitcnt vmcnt(5)
    buffer_load_dwordx4 a[4:7], v2, s[28:31], s72 offen offset:128 nt
    v_mfma_f32_16x16x32_bf16 v[76:79], v[28:31], a[236:239], v[76:79]
    v_cndmask_b32 v125, v72, v68, s[76:77]
    v_cndmask_b32 v126, v73, v69, s[76:77]
    v_cndmask_b32 v127, v74, v70, s[76:77]
    v_cndmask_b32 v128, v75, v71, s[76:77]
    v_permlane16_swap_b32 v125, v126
    s_nop 0
    v_permlane16_swap_b32 v127, v128
    v_add_f32_dpp v125, v126, v125 quad_perm:[1,0,3,2] row_mask:0xf bank_mask:0xf
    s_nop 0
    v_add_f32_dpp v127, v128, v127 quad_perm:[1,0,3,2] row_mask:0xf bank_mask:0xf
    v_cvt_pk_bf16_f32 v125, v125, v127
    v_and_b32 v126, s5, v125
    v_lshlrev_b32 v125, 16, v125
    v_mul_f32 v126, s4, v126
    v_mul_f32 v125, s4, v125
    v_cvt_pk_bf16_f32 v125, v125, v126
    v_lshlrev_b32 v60, 16, v125
    v_and_b32 v61, s5, v125
    v_max_f32 v116, v116, v60
    v_max_f32 v117, v117, v61
    s_cbranch_vccnz L_s130
L_b130:
    s_waitcnt vmcnt(5)
    buffer_load_dwordx4 a[8:11], v2, s[28:31], s72 offen offset:2048 nt
    v_mfma_f32_16x16x32_bf16 v[80:83], v[16:19], a[240:243], 0
    s_cbranch_vccnz L_s131
L_b131:
    s_waitcnt vmcnt(5)
    buffer_load_dwordx4 a[12:15], v2, s[28:31], s72 offen offset:2176 nt
    v_mfma_f32_16x16x32_bf16 v[80:83], v[24:27], a[244:247], v[80:83]
    s_add_u32 s72, s101, 1982464
    s_cbranch_vccnz L_s132
L_b132:
    s_waitcnt vmcnt(5)
    buffer_load_dwordx4 a[16:19], v3, s[28:31], s72 offen offset:0 nt
    v_mfma_f32_16x16x32_bf16 v[80:83], v[20:23], a[248:251], v[80:83]
    s_cbranch_vccnz L_s133
L_b133:
    s_waitcnt vmcnt(5)
    buffer_load_dwordx4 a[20:23], v3, s[28:31], s72 offen offset:128 nt
    v_mfma_f32_16x16x32_bf16 v[80:83], v[28:31], a[252:255], v[80:83]
    s_cbranch_vccnz L_s134
L_b134:
    s_waitcnt vmcnt(5)
    buffer_load_dwordx4 a[24:27], v3, s[28:31], s72 offen offset:2048 nt
    s_cmp_lg_u32 s3, 1
    s_cbranch_scc1 L_ng5
    s_waitcnt lgkmcnt(0)
    s_cmp_eq_u32 s100, 0
    s_cselect_b32 s7, -3, 0
    s_cmp_eq_u32 s64, s6
    s_addc_u32 s7, s7, 0
    s_cmp_eq_u32 s65, s6
    s_addc_u32 s7, s7, 0
    s_cmp_eq_u32 s66, s6
    s_addc_u32 s7, s7, 0
    s_cmp_eq_u32 s67, s6
    s_addc_u32 s7, s7, 0
    s_cmp_eq_u32 s68, s6
    s_addc_u32 s7, s7, 0
    s_cmp_eq_u32 s69, s6
    s_addc_u32 s7, s7, 0
    s_cmp_eq_u32 s70, s6
    s_addc_u32 s7, s7, 0
    s_cmp_eq_u32 s71, s6
    s_addc_u32 s7, s7, 0
    s_cmp_lt_i32 s7, 4
    s_cselect_b32 s21, 1, 0
    v_mov_b32 v137, s21
    ds_write_b32 v243, v137
L_ng5:
    v_mfma_f32_16x16x32_bf16 v[68:71], v[16:19], a[0:3], 0
    s_cbranch_vccnz L_s135
L_b135:
    s_waitcnt vmcnt(5)
    buffer_load_dwordx4 a[28:31], v3, s[28:31], s72 offen offset:2176 nt
    v_mfma_f32_16x16x32_bf16 v[68:71], v[24:27], a[4:7], v[68:71]
    s_add_u32 s72, s101, 393216
    s_cbranch_vccnz L_s136
L_b136:
    s_waitcnt vmcnt(5)
    buffer_load_dwordx4 a[32:35], v4, s[32:35], s72 offen offset:0 nt
    ds_read_b32 v137, v243
    v_mfma_f32_16x16x32_bf16 v[68:71], v[20:23], a[8:11], v[68:71]
    s_cbranch_vccnz L_s137
L_b137:
    s_waitcnt vmcnt(5)
    buffer_load_dwordx4 a[36:39], v4, s[32:35], s72 offen offset:1024 nt
    s_waitcnt lgkmcnt(0)
    v_readfirstlane_b32 s21, v137
    s_and_b32 s21, s21, 3
    s_cmp_lg_u32 s21, 0
    s_cselect_b64 vcc, -1, 0
    v_mfma_f32_16x16x32_bf16 v[68:71], v[28:31], a[12:15], v[68:71]
    v_cndmask_b32 v125, v80, v76, s[76:77]
    v_cndmask_b32 v126, v81, v77, s[76:77]
    v_cndmask_b32 v127, v82, v78, s[76:77]
    v_cndmask_b32 v128, v83, v79, s[76:77]
    v_permlane16_swap_b32 v125, v126
    s_nop 0
    v_permlane16_swap_b32 v127, v128
    v_add_f32_dpp v125, v126, v125 quad_perm:[1,0,3,2] row_mask:0xf bank_mask:0xf
    s_nop 0
    v_add_f32_dpp v127, v128, v127 quad_perm:[1,0,3,2] row_mask:0xf bank_mask:0xf
    v_cvt_pk_bf16_f32 v125, v125, v127
    v_and_b32 v126, s5, v125
    v_lshlrev_b32 v125, 16, v125
    v_mul_f32 v126, s4, v126
    v_mul_f32 v125, s4, v125
    v_cvt_pk_bf16_f32 v125, v125, v126
    v_lshlrev_b32 v62, 16, v125
    v_and_b32 v63, s5, v125
    v_max_f32 v116, v116, v62
    v_max_f32 v117, v117, v63
    s_cbranch_vccnz L_s138
L_b138:
    s_waitcnt vmcnt(5)
    buffer_load_dwordx4 a[40:43], v4, s[32:35], s72 offen offset:2048 nt
    v_mfma_f32_16x16x32_bf16 v[72:75], v[16:19], a[16:19], 0
    s_cbranch_vccnz L_s139
L_b139:
    s_waitcnt vmcnt(5)
    buffer_load_dwordx4 a[44:47], v4, s[32:35], s72 offen offset:3072 nt
    v_mfma_f32_16x16x32_bf16 v[72:75], v[24:27], a[20:23], v[72:75]
    s_add_u32 s72, s101, 409600
    s_cbranch_vccnz L_s140
L_b140:
    s_waitcnt vmcnt(5)
    buffer_load_dwordx4 a[48:51], v4, s[32:35], s72 offen offset:0 nt
    v_mfma_f32_16x16x32_bf16 v[72:75], v[20:23], a[24:27], v[72:75]
    s_cbranch_vccnz L_s141
L_b141:
    s_waitcnt vmcnt(5)
    buffer_load_dwordx4 a[52:55], v4, s[32:35], s72 offen offset:1024 nt
    v_mfma_f32_16x16x32_bf16 v[72:75], v[28:31], a[28:31], v[72:75]
    s_nop 7
    v_cndmask_b32 v125, v72, v68, s[76:77]
    v_cndmask_b32 v126, v73, v69, s[76:77]
    v_cndmask_b32 v127, v74, v70, s[76:77]
    v_cndmask_b32 v128, v75, v71, s[76:77]
    v_permlane16_swap_b32 v125, v126
    s_nop 0
    v_permlane16_swap_b32 v127, v128
    v_add_f32_dpp v125, v126, v125 quad_perm:[1,0,3,2] row_mask:0xf bank_mask:0xf
    s_nop 0
    v_add_f32_dpp v127, v128, v127 quad_perm:[1,0,3,2] row_mask:0xf bank_mask:0xf
    v_cvt_pk_bf16_f32 v125, v125, v127
    v_and_b32 v126, s5, v125
    v_lshlrev_b32 v125, 16, v125
    v_mul_f32 v126, s4, v126
    v_mul_f32 v125, s4, v125
    v_cvt_pk_bf16_f32 v125, v125, v126
    v_lshlrev_b32 v64, 16, v125
    v_and_b32 v65, s5, v125
    v_max_f32 v116, v116, v64
    v_max_f32 v117, v117, v65
    s_cbranch_vccnz L_s142
L_b142:
    s_waitcnt vmcnt(5)
    buffer_load_dwordx4 a[56:59], v4, s[32:35], s72 offen offset:2048 nt
    s_cmp_lg_u32 s3, 2
    s_cbranch_scc1 L_np6
    s_and_b32 s7, s2, 7
    s_mul_i32 s8, s7, 23
    s_lshr_b32 s22, s2, 3
    s_add_u32 s22, s22, s8
    s_add_u32 s22, s22, 2
    s_and_b32 s0, s22, 31
    s_and_b32 s22, s22, 31
    s_lshl_b32 s22, s22, 7
    s_add_u32 s22, s22, 417792
    s_load_dwordx8 s[64:71], s[26:27], s22 glc
    s_lshl_b32 s7, s7, 2
    s_xor_b32 s22, s22, 2048
    s_add_u32 s22, s22, s7
    s_atomic_swap s6, s[26:27], s22
L_np6:
    v_max_f32_dpp v116, v116, v116 row_ror:8 row_mask:0xf bank_mask:0xf
    v_max_f32_dpp v117, v117, v117 row_ror:8 row_mask:0xf bank_mask:0xf
    s_nop 0
    v_max_f32_dpp v116, v116, v116 row_ror:4 row_mask:0xf bank_mask:0xf
    v_max_f32_dpp v117, v117, v117 row_ror:4 row_mask:0xf bank_mask:0xf
    s_nop 0
    v_max_f32_dpp v116, v116, v116 row_ror:2 row_mask:0xf bank_mask:0xf
    v_max_f32_dpp v117, v117, v117 row_ror:2 row_mask:0xf bank_mask:0xf
    s_nop 0
    v_max_f32_dpp v116, v116, v116 row_ror:1 row_mask:0xf bank_mask:0xf
    v_max_f32_dpp v117, v117, v117 row_ror:1 row_mask:0xf bank_mask:0xf
    v_mov_b32 v125, v116
    v_mov_b32 v126, v117
    s_nop 0
    v_permlane32_swap_b32 v116, v125
    v_permlane32_swap_b32 v117, v126
    v_max_f32 v116, v116, v125
    v_max_f32 v117, v117, v126
    v_mul_f32 v120, s75, v116
    v_mul_f32 v121, s75, v117
    v_fma_f32 v125, v40, s75, -v120
    v_fma_f32 v126, v41, s75, -v121
    v_exp_f32 v125, v125
    v_exp_f32 v126, v126
    v_add_f32 v118, v118, v125
    v_add_f32 v119, v119, v126
    v_cvt_pk_bf16_f32 v127, v125, v126
    ds_write_b32 v5, v127 offset:1024
    v_fma_f32 v125, v42, s75, -v120
    v_fma_f32 v126, v43, s75, -v121
    v_exp_f32 v125, v125
    v_exp_f32 v126, v126
    v_add_f32 v118, v118, v125
    v_add_f32 v119, v119, v126
    v_cvt_pk_bf16_f32 v127, v125, v126
    ds_write_b32 v5, v127 offset:1280
    s_cbranch_vccnz L_s143
L_b143:
    s_waitcnt vmcnt(5)
    buffer_load_dwordx4 a[60:63], v4, s[32:35], s72 offen offset:3072 nt
    v_fma_f32 v125, v44, s75, -v120
    v_fma_f32 v126, v45, s75, -v121
    v_exp_f32 v125, v125
    v_exp_f32 v126, v126
    v_add_f32 v118, v118, v125
    v_add_f32 v119, v119, v126
    v_cvt_pk_bf16_f32 v127, v125, v126
    ds_write_b32 v5, v127 offset:1536
    ds_read_b128 v[156:159], v6 offset:1024
    ds_read_b128 v[160:163], v6 offset:1040
    ds_read_b128 v[164:167], v6 offset:1280
    ds_read_b128 v[168:171], v6 offset:1296
    s_waitcnt lgkmcnt(0)
    v_perm_b32 v100, v156, v156, v8
    v_perm_b32 v101, v156, v156, v9
    v_perm_b32 v102, v156, v156, v10
    v_perm_b32 v103, v156, v156, v11
    v_perm_b32 v104, v156, v156, v12
    v_perm_b32 v105, v156, v156, v13
    v_perm_b32 v106, v156, v156, v14
    v_perm_b32 v107, v156, v156, v15
    v_mfma_f32_16x16x32_bf16 v[108:111], v[100:103], a[32:35], 0
    s_nop 0
    v_mfma_f32_16x16x32_bf16 v[112:115], v[104:107], a[32:35], 0
    v_fma_f32 v125, v46, s75, -v120
    v_fma_f32 v126, v47, s75, -v121
    v_exp_f32 v125, v125
    v_exp_f32 v126, v126
    v_add_f32 v118, v118, v125
    v_add_f32 v119, v119, v126
    v_cvt_pk_bf16_f32 v127, v125, v126
    ds_write_b32 v5, v127 offset:1792
    s_add_u32 s72, s101, 524288
    s_cbranch_vccnz L_s144
L_b144:
    s_waitcnt vmcnt(5)
    buffer_load_dwordx4 a[64:67], v4, s[32:35], s72 offen offset:0 nt
    v_perm_b32 v100, v157, v157, v8
    v_perm_b32 v101, v157, v157, v9
    v_perm_b32 v102, v157, v157, v10
    v_perm_b32 v103, v157, v157, v11
    v_perm_b32 v104, v157, v157, v12
    v_perm_b32 v105, v157, v157, v13
    v_perm_b32 v106, v157, v157, v14
    v_perm_b32 v107, v157, v157, v15
    v_mfma_f32_16x16x32_bf16 v[108:111], v[100:103], a[36:39], v[108:111]
    s_nop 0
    v_mfma_f32_16x16x32_bf16 v[112:115], v[104:107], a[36:39], v[112:115]
    v_perm_b32 v100, v158, v158, v8
    v_perm_b32 v101, v158, v158, v9
    v_perm_b32 v102, v158, v158, v10
    v_perm_b32 v103, v158, v158, v11
    v_perm_b32 v104, v158, v158, v12
    v_perm_b32 v105, v158, v158, v13
    v_perm_b32 v106, v158, v158, v14
    v_perm_b32 v107, v158, v158, v15
    v_mfma_f32_16x16x32_bf16 v[108:111], v[100:103], a[40:43], v[108:111]
    s_nop 0
    v_mfma_f32_16x16x32_bf16 v[112:115], v[104:107], a[40:43], v[112:115]
    v_fma_f32 v125, v48, s75, -v120
    v_fma_f32 v126, v49, s75, -v121
    v_exp_f32 v125, v125
    v_exp_f32 v126, v126
    v_add_f32 v118, v118, v125
    v_add_f32 v119, v119, v126
    v_cvt_pk_bf16_f32 v127, v125, v126
    ds_write_b32 v5, v127 offset:2048
    s_cbranch_vccnz L_s145
L_b145:
    s_waitcnt vmcnt(5)
    buffer_load_dwordx4 a[68:71], v4, s[32:35], s72 offen offset:1024 nt
    s_lshr_b32 s7, s2, 3
    s_and_b32 s7, s7, 15
    s_cmp_lg_u32 s7, 4
    s_cbranch_scc1 L_nr4
    s_getpc_b64 s[0:1]
L_rp4:
    s_add_u32 s0, s0, 1536
    s_addc_u32 s1, s1, 0
    global_load_dwordx4 v[228:231], v255, s[0:1]
L_nr4:
    v_perm_b32 v100, v159, v159, v8
    v_perm_b32 v101, v159, v159, v9
    v_perm_b32 v102, v159, v159, v10
    v_perm_b32 v103, v159, v159, v11
    v_perm_b32 v104, v159, v159, v12
    v_perm_b32 v105, v159, v159, v13
    v_perm_b32 v106, v159, v159, v14
    v_perm_b32 v107, v159, v159, v15
    v_mfma_f32_16x16x32_bf16 v[108:111], v[100:103], a[44:47], v[108:111]
    s_nop 0
    v_mfma_f32_16x16x32_bf16 v[112:115], v[104:107], a[44:47], v[112:115]
    v_perm_b32 v100, v160, v160, v8
    v_perm_b32 v101, v160, v160, v9
    v_perm_b32 v102, v160, v160, v10
    v_perm_b32 v103, v160, v160, v11
    v_perm_b32 v104, v160, v160, v12
    v_perm_b32 v105, v160, v160, v13
    v_perm_b32 v106, v160, v160, v14
    v_perm_b32 v107, v160, v160, v15
    s_cbranch_vccnz L_s146
L_b146:
    s_waitcnt vmcnt(5)
    buffer_load_dwordx4 a[72:75], v4, s[32:35], s72 offen offset:2048 nt
    v_mfma_f32_16x16x32_bf16 v[108:111], v[100:103], a[48:51], v[108:111]
    v_mfma_f32_16x16x32_bf16 v[112:115], v[104:107], a[48:51], v[112:115]
    v_fma_f32 v125, v50, s75, -v120
    v_fma_f32 v126, v51, s75, -v121
    v_exp_f32 v125, v125
    v_exp_f32 v126, v126
    v_add_f32 v118, v118, v125
    v_add_f32 v119, v119, v126
    v_cvt_pk_bf16_f32 v127, v125, v126
    ds_write_b32 v5, v127 offset:2304
    v_perm_b32 v100, v161, v161, v8
    v_perm_b32 v101, v161, v161, v9
    v_perm_b32 v102, v161, v161, v10
    v_perm_b32 v103, v161, v161, v11
    v_perm_b32 v104, v161, v161, v12
    v_perm_b32 v105, v161, v161, v13
    v_perm_b32 v106, v161, v161, v14
    v_perm_b32 v107, v161, v161, v15
    s_cbranch_vccnz L_s147
L_b147:
    s_waitcnt vmcnt(5)
    buffer_load_dwordx4 a[76:79], v4, s[32:35], s72 offen offset:3072 nt
    v_mfma_f32_16x16x32_bf16 v[108:111], v[100:103], a[52:55], v[108:111]
    v_mfma_f32_16x16x32_bf16 v[112:115], v[104:107], a[52:55], v[112:115]
    v_perm_b32 v100, v162, v162, v8
    v_perm_b32 v101, v162, v162, v9
    v_perm_b32 v102, v162, v162, v10
    v_perm_b32 v103, v162, v162, v11
    v_perm_b32 v104, v162, v162, v12
    v_perm_b32 v105, v162, v162, v13
    v_perm_b32 v106, v162, v162, v14
    v_perm_b32 v107, v162, v162, v15
    s_add_u32 s72, s101, 540672
    s_cbranch_vccnz L_s148
L_b148:
    s_waitcnt vmcnt(5)
    buffer_load_dwordx4 a[80:83], v4, s[32:35], s72 offen offset:0 nt
    v_mfma_f32_16x16x32_bf16 v[108:111], v[100:103], a[56:59], v[108:111]
    v_mfma_f32_16x16x32_bf16 v[112:115], v[104:107], a[56:59], v[112:115]
    v_fma_f32 v125, v52, s75, -v120
    v_fma_f32 v126, v53, s75, -v121
    v_exp_f32 v125, v125
    v_exp_f32 v126, v126
    v_add_f32 v118, v118, v125
    v_add_f32 v119, v119, v126
    v_cvt_pk_bf16_f32 v127, v125, v126
    ds_write_b32 v5, v127 offset:2560
    v_perm_b32 v100, v163, v163, v8
    v_perm_b32 v101, v163, v163, v9
    v_perm_b32 v102, v163, v163, v10
    v_perm_b32 v103, v163, v163, v11
    v_perm_b32 v104, v163, v163, v12
    v_perm_b32 v105, v163, v163, v13
    v_perm_b32 v106, v163, v163, v14
    v_perm_b32 v107, v163, v163, v15
    s_cbranch_vccnz L_s149
L_b149:
    s_waitcnt vmcnt(5)
    buffer_load_dwordx4 a[84:87], v4, s[32:35], s72 offen offset:1024 nt
    v_mfma_f32_16x16x32_bf16 v[108:111], v[100:103], a[60:63], v[108:111]
    v_mfma_f32_16x16x32_bf16 v[112:115], v[104:107], a[60:63], v[112:115]
    v_perm_b32 v100, v164, v164, v8
    v_perm_b32 v101, v164, v164, v9
    v_perm_b32 v102, v164, v164, v10
    v_perm_b32 v103, v164, v164, v11
    v_perm_b32 v104, v164, v164, v12
    v_perm_b32 v105, v164, v164, v13
    v_perm_b32 v106, v164, v164, v14
    v_perm_b32 v107, v164, v164, v15
    s_cbranch_vccnz L_s150
L_b150:
    s_waitcnt vmcnt(5)
    buffer_load_dwordx4 a[88:91], v4, s[32:35], s72 offen offset:2048 nt
    s_lshr_b32 s7, s2, 3
    s_and_b32 s7, s7, 15
    s_cmp_lg_u32 s7, 13
    s_cbranch_scc1 L_nr9
    s_getpc_b64 s[0:1]
L_rp9:
    s_add_u32 s0, s0, L_end-L_rp9
    s_addc_u32 s1, s1, 0
    global_load_dwordx4 v[228:231], v255, s[0:1]
L_nr9:
    s_cmp_lg_u32 s3, 2
    s_cbranch_scc1 L_ng6
    s_waitcnt lgkmcnt(0)
    s_cmp_eq_u32 s100, 0
    s_cselect_b32 s7, -3, 0
    s_cmp_eq_u32 s64, s6
    s_addc_u32 s7, s7, 0
    s_cmp_eq_u32 s65, s6
    s_addc_u32 s7, s7, 0
    s_cmp_eq_u32 s66, s6
    s_addc_u32 s7, s7, 0
    s_cmp_eq_u32 s67, s6
    s_addc_u32 s7, s7, 0
    s_cmp_eq_u32 s68, s6
    s_addc_u32 s7, s7, 0
    s_cmp_eq_u32 s69, s6
    s_addc_u32 s7, s7, 0
    s_cmp_eq_u32 s70, s6
    s_addc_u32 s7, s7, 0
    s_cmp_eq_u32 s71, s6
    s_addc_u32 s7, s7, 0
    s_cmp_lt_i32 s7, 4
    s_cselect_b32 s21, 1, 0
    v_mov_b32 v137, s21
    ds_write_b32 v243, v137
L_ng6:
    v_mfma_f32_16x16x32_bf16 v[108:111], v[100:103], a[64:67], v[108:111]
    v_mfma_f32_16x16x32_bf16 v[112:115], v[104:107], a[64:67], v[112:115]
    v_fma_f32 v125, v54, s75, -v120
    v_fma_f32 v126, v55, s75, -v121
    v_exp_f32 v125, v125
    v_exp_f32 v126, v126
    v_add_f32 v118, v118, v125
    v_add_f32 v119, v119, v126
    v_cvt_pk_bf16_f32 v127, v125, v126
    ds_write_b32 v5, v127 offset:2816
    v_perm_b32 v100, v165, v165, v8
    v_perm_b32 v101, v165, v165, v9
    v_perm_b32 v102, v165, v165, v10
    v_perm_b32 v103, v165, v165, v11
    v_perm_b32 v104, v165, v165, v12
    v_perm_b32 v105, v165, v165, v13
    v_perm_b32 v106, v165, v165, v14
    v_perm_b32 v107, v165, v165, v15
    s_cbranch_vccnz L_s151
L_b151:
    s_waitcnt vmcnt(5)
    buffer_load_dwordx4 a[92:95], v4, s[32:35], s72 offen offset:3072 nt
    v_mfma_f32_16x16x32_bf16 v[108:111], v[100:103], a[68:71], v[108:111]
    v_mfma_f32_16x16x32_bf16 v[112:115], v[104:107], a[68:71], v[112:115]
    v_perm_b32 v100, v166, v166, v8
    v_perm_b32 v101, v166, v166, v9
    v_perm_b32 v102, v166, v166, v10
    v_perm_b32 v103, v166, v166, v11
    v_perm_b32 v104, v166, v166, v12
    v_perm_b32 v105, v166, v166, v13
    v_perm_b32 v106, v166, v166, v14
    v_perm_b32 v107, v166, v166, v15
    s_add_u32 s72, s101, 655360
    s_cbranch_vccnz L_s152
L_b152:
    s_waitcnt vmcnt(5)
    buffer_load_dwordx4 a[96:99], v4, s[32:35], s72 offen offset:0 nt
    ds_read_b32 v137, v243
    v_mfma_f32_16x16x32_bf16 v[108:111], v[100:103], a[72:75], v[108:111]
    v_mfma_f32_16x16x32_bf16 v[112:115], v[104:107], a[72:75], v[112:115]
    v_fma_f32 v125, v56, s75, -v120
    v_fma_f32 v126, v57, s75, -v121
    v_exp_f32 v125, v125
    v_exp_f32 v126, v126
    v_add_f32 v118, v118, v125
    v_add_f32 v119, v119, v126
    v_cvt_pk_bf16_f32 v127, v125, v126
    ds_write_b32 v5, v127 offset:3072
    v_perm_b32 v100, v167, v167, v8
    v_perm_b32 v101, v167, v167, v9
    v_perm_b32 v102, v167, v167, v10
    v_perm_b32 v103, v167, v167, v11
    v_perm_b32 v104, v167, v167, v12
    v_perm_b32 v105, v167, v167, v13
    v_perm_b32 v106, v167, v167, v14
    v_perm_b32 v107, v167, v167, v15
    s_cbranch_vccnz L_s153
L_b153:
    s_waitcnt vmcnt(5)
    buffer_load_dwordx4 a[100:103], v4, s[32:35], s72 offen offset:1024 nt
    s_waitcnt lgkmcnt(0)
    v_readfirstlane_b32 s21, v137
    s_and_b32 s21, s21, 3
    s_cmp_lg_u32 s21, 0
    s_cselect_b64 vcc, -1, 0
    v_mfma_f32_16x16x32_bf16 v[108:111], v[100:103], a[76:79], v[108:111]
    v_mfma_f32_16x16x32_bf16 v[112:115], v[104:107], a[76:79], v[112:115]
    v_perm_b32 v100, v168, v168, v8
    v_perm_b32 v101, v168, v168, v9
    v_perm_b32 v102, v168, v168, v10
    v_perm_b32 v103, v168, v168, v11
    v_perm_b32 v104, v168, v168, v12
    v_perm_b32 v105, v168, v168, v13
    v_perm_b32 v106, v168, v168, v14
    v_perm_b32 v107, v168, v168, v15
    s_cbranch_vccnz L_s154
L_b154:
    s_waitcnt vmcnt(5)
    buffer_load_dwordx4 a[104:107], v4, s[32:35], s72 offen offset:2048 nt
    v_mfma_f32_16x16x32_bf16 v[108:111], v[100:103], a[80:83], v[108:111]
    v_mfma_f32_16x16x32_bf16 v[112:115], v[104:107], a[80:83], v[112:115]
    ds_read_b128 v[172:175], v6 offset:1536
    ds_read_b128 v[176:179], v6 offset:1552
    ds_read_b128 v[180:183], v6 offset:1792
    ds_read_b128 v[184:187], v6 offset:1808
    v_fma_f32 v125, v58, s75, -v120
    v_fma_f32 v126, v59, s75, -v121
    v_exp_f32 v125, v125
    v_exp_f32 v126, v126
    v_add_f32 v118, v118, v125
    v_add_f32 v119, v119, v126
    v_cvt_pk_bf16_f32 v127, v125, v126
    ds_write_b32 v5, v127 offset:3328
    v_perm_b32 v100, v169, v169, v8
    v_perm_b32 v101, v169, v169, v9
    v_perm_b32 v102, v169, v169, v10
    v_perm_b32 v103, v169, v169, v11
    v_perm_b32 v104, v169, v169, v12
    v_perm_b32 v105, v169, v169, v13
    v_perm_b32 v106, v169, v169, v14
    v_perm_b32 v107, v169, v169, v15
    s_cbranch_vccnz L_s155
L_b155:
    s_waitcnt vmcnt(5)
    buffer_load_dwordx4 a[108:111], v4, s[32:35], s72 offen offset:3072 nt
    v_mfma_f32_16x16x32_bf16 v[108:111], v[100:103], a[84:87], v[108:111]
    v_mfma_f32_16x16x32_bf16 v[112:115], v[104:107], a[84:87], v[112:115]
    v_perm_b32 v100, v170, v170, v8
    v_perm_b32 v101, v170, v170, v9
    v_perm_b32 v102, v170, v170, v10
    v_perm_b32 v103, v170, v170, v11
    v_perm_b32 v104, v170, v170, v12
    v_perm_b32 v105, v170, v170, v13
    v_perm_b32 v106, v170, v170, v14
    v_perm_b32 v107, v170, v170, v15
    s_add_u32 s72, s101, 671744
    s_cbranch_vccnz L_s156
L_b156:
    s_waitcnt vmcnt(5)
    buffer_load_dwordx4 a[112:115], v4, s[32:35], s72 offen offset:0 nt
    v_mfma_f32_16x16x32_bf16 v[108:111], v[100:103], a[88:91], v[108:111]
    v_mfma_f32_16x16x32_bf16 v[112:115], v[104:107], a[88:91], v[112:115]
    v_fma_f32 v125, v60, s75, -v120
    v_fma_f32 v126, v61, s75, -v121
    v_exp_f32 v125, v125
    v_exp_f32 v126, v126
    v_add_f32 v118, v118, v125
    v_add_f32 v119, v119, v126
    v_cvt_pk_bf16_f32 v127, v125, v126
    ds_write_b32 v5, v127 offset:3584
    v_perm_b32 v100, v171, v171, v8
    v_perm_b32 v101, v171, v171, v9
    v_perm_b32 v102, v171, v171, v10
    v_perm_b32 v103, v171, v171, v11
    v_perm_b32 v104, v171, v171, v12
    v_perm_b32 v105, v171, v171, v13
    v_perm_b32 v106, v171, v171, v14
    v_perm_b32 v107, v171, v171, v15
    s_cbranch_vccnz L_s157
L_b157:
    s_waitcnt vmcnt(5)
    buffer_load_dwordx4 a[116:119], v4, s[32:35], s72 offen offset:1024 nt
    v_mfma_f32_16x16x32_bf16 v[108:111], v[100:103], a[92:95], v[108:111]
    v_mfma_f32_16x16x32_bf16 v[112:115], v[104:107], a[92:95], v[112:115]
    s_waitcnt lgkmcnt(0)
    v_perm_b32 v100, v172, v172, v8
    v_perm_b32 v101, v172, v172, v9
    v_perm_b32 v102, v172, v172, v10
    v_perm_b32 v103, v172, v172, v11
    v_perm_b32 v104, v172, v172, v12
    v_perm_b32 v105, v172, v172, v13
    v_perm_b32 v106, v172, v172, v14
    v_perm_b32 v107, v172, v172, v15
    s_cbranch_vccnz L_s158
L_b158:
    s_waitcnt vmcnt(5)
    buffer_load_dwordx4 a[120:123], v4, s[32:35], s72 offen offset:2048 nt
    s_cmp_lg_u32 s3, 3
    s_cbranch_scc1 L_np7
    s_and_b32 s7, s2, 7
    s_mul_i32 s8, s7, 26
    s_lshr_b32 s22, s2, 3
    s_add_u32 s22, s22, s8
    s_add_u32 s22, s22, 13
    s_and_b32 s0, s22, 31
    s_and_b32 s22, s22, 31
    s_lshl_b32 s22, s22, 7
    s_add_u32 s22, s22, 421888
    s_load_dwordx8 s[64:71], s[26:27], s22 glc
    s_lshl_b32 s7, s7, 2
    s_xor_b32 s22, s22, 2048
    s_add_u32 s22, s22, s7
    s_atomic_swap s6, s[26:27], s22
L_np7:
    v_mfma_f32_16x16x32_bf16 v[108:111], v[100:103], a[96:99], v[108:111]
    v_mfma_f32_16x16x32_bf16 v[112:115], v[104:107], a[96:99], v[112:115]
    v_fma_f32 v125, v62, s75, -v120
    v_fma_f32 v126, v63, s75, -v121
    v_exp_f32 v125, v125
    v_exp_f32 v126, v126
    v_add_f32 v118, v118, v125
    v_add_f32 v119, v119, v126
    v_cvt_pk_bf16_f32 v127, v125, v126
    ds_write_b32 v5, v127 offset:3840
    v_perm_b32 v100, v173, v173, v8
    v_perm_b32 v101, v173, v173, v9
    v_perm_b32 v102, v173, v173, v10
    v_perm_b32 v103, v173, v173, v11
    v_perm_b32 v104, v173, v173, v12
    v_perm_b32 v105, v173, v173, v13
    v_perm_b32 v106, v173, v173, v14
    v_perm_b32 v107, v173, v173, v15
    s_cbranch_vccnz L_s159
L_b159:
    s_waitcnt vmcnt(5)
    buffer_load_dwordx4 a[124:127], v4, s[32:35], s72 offen offset:3072 nt
    v_mfma_f32_16x16x32_bf16 v[108:111], v[100:103], a[100:103], v[108:111]
    v_mfma_f32_16x16x32_bf16 v[112:115], v[104:107], a[100:103], v[112:115]
    v_perm_b32 v100, v174, v174, v8
    v_perm_b32 v101, v174, v174, v9
    v_perm_b32 v102, v174, v174, v10
    v_perm_b32 v103, v174, v174, v11
    v_perm_b32 v104, v174, v174, v12
    v_perm_b32 v105, v174, v174, v13
    v_perm_b32 v106, v174, v174, v14
    v_perm_b32 v107, v174, v174, v15
    s_add_u32 s72, s101, 786432
    s_cbranch_vccnz L_s160
L_b160:
    s_waitcnt vmcnt(5)
    buffer_load_dwordx4 a[0:3], v4, s[32:35], s72 offen offset:0 nt
    v_mfma_f32_16x16x32_bf16 v[108:111], v[100:103], a[104:107], v[108:111]
    v_mfma_f32_16x16x32_bf16 v[112:115], v[104:107], a[104:107], v[112:115]
    v_fma_f32 v125, v64, s75, -v120
    v_fma_f32 v126, v65, s75, -v121
    v_exp_f32 v125, v125
    v_exp_f32 v126, v126
    v_add_f32 v118, v118, v125
    v_add_f32 v119, v119, v126
    v_cvt_pk_bf16_f32 v127, v125, v126
    ds_write_b32 v5, v127 offset:4096
    v_perm_b32 v100, v175, v175, v8
    v_perm_b32 v101, v175, v175, v9
    v_perm_b32 v102, v175, v175, v10
    v_perm_b32 v103, v175, v175, v11
    v_perm_b32 v104, v175, v175, v12
    v_perm_b32 v105, v175, v175, v13
    v_perm_b32 v106, v175, v175, v14
    v_perm_b32 v107, v175, v175, v15
    s_cbranch_vccnz L_s161
L_b161:
    s_waitcnt vmcnt(5)
    buffer_load_dwordx4 a[4:7], v4, s[32:35], s72 offen offset:1024 nt
    v_mfma_f32_16x16x32_bf16 v[108:111], v[100:103], a[108:111], v[108:111]
    v_mfma_f32_16x16x32_bf16 v[112:115], v[104:107], a[108:111], v[112:115]
    v_perm_b32 v100, v176, v176, v8
    v_perm_b32 v101, v176, v176, v9
    v_perm_b32 v102, v176, v176, v10
    v_perm_b32 v103, v176, v176, v11
    v_perm_b32 v104, v176, v176, v12
    v_perm_b32 v105, v176, v176, v13
    v_perm_b32 v106, v176, v176, v14
    v_perm_b32 v107, v176, v176, v15
    s_cbranch_vccnz L_s162
L_b162:
    s_waitcnt vmcnt(5)
    buffer_load_dwordx4 a[8:11], v4, s[32:35], s72 offen offset:2048 nt
    v_mfma_f32_16x16x32_bf16 v[108:111], v[100:103], a[112:115], v[108:111]
    v_mfma_f32_16x16x32_bf16 v[112:115], v[104:107], a[112:115], v[112:115]
    v_fma_f32 v125, v32, s75, -v120
    v_fma_f32 v126, v33, s75, -v121
    v_exp_f32 v125, v125
    v_exp_f32 v126, v126
    v_add_f32 v118, v118, v125
    v_add_f32 v119, v119, v126
    v_cvt_pk_bf16_f32 v127, v125, v126
    ds_write_b32 v5, v127 offset:0
    v_perm_b32 v100, v177, v177, v8
    v_perm_b32 v101, v177, v177, v9
    v_perm_b32 v102, v177, v177, v10
    v_perm_b32 v103, v177, v177, v11
    v_perm_b32 v104, v177, v177, v12
    v_perm_b32 v105, v177, v177, v13
    v_perm_b32 v106, v177, v177, v14
    v_perm_b32 v107, v177, v177, v15
    s_cbranch_vccnz L_s163
L_b163:
    s_waitcnt vmcnt(5)
    buffer_load_dwordx4 a[12:15], v4, s[32:35], s72 offen offset:3072 nt
    v_mfma_f32_16x16x32_bf16 v[108:111], v[100:103], a[116:119], v[108:111]
    v_mfma_f32_16x16x32_bf16 v[112:115], v[104:107], a[116:119], v[112:115]
    v_perm_b32 v100, v178, v178, v8
    v_perm_b32 v101, v178, v178, v9
    v_perm_b32 v102, v178, v178, v10
    v_perm_b32 v103, v178, v178, v11
    v_perm_b32 v104, v178, v178, v12
    v_perm_b32 v105, v178, v178, v13
    v_perm_b32 v106, v178, v178, v14
    v_perm_b32 v107, v178, v178, v15
    s_add_u32 s72, s101, 802816
    s_cbranch_vccnz L_s164
L_b164:
    s_waitcnt vmcnt(5)
    buffer_load_dwordx4 a[16:19], v4, s[32:35], s72 offen offset:0 nt
    v_mfma_f32_16x16x32_bf16 v[108:111], v[100:103], a[120:123], v[108:111]
    v_mfma_f32_16x16x32_bf16 v[112:115], v[104:107], a[120:123], v[112:115]
    v_fma_f32 v125, v34, s75, -v120
    v_fma_f32 v126, v35, s75, -v121
    v_exp_f32 v125, v125
    v_exp_f32 v126, v126
    v_add_f32 v118, v118, v125
    v_add_f32 v119, v119, v126
    v_cvt_pk_bf16_f32 v127, v125, v126
    ds_write_b32 v5, v127 offset:256
    v_perm_b32 v100, v179, v179, v8
    v_perm_b32 v101, v179, v179, v9
    v_perm_b32 v102, v179, v179, v10
    v_perm_b32 v103, v179, v179, v11
    v_perm_b32 v104, v179, v179, v12
    v_perm_b32 v105, v179, v179, v13
    v_perm_b32 v106, v179, v179, v14
    v_perm_b32 v107, v179, v179, v15
    s_cbranch_vccnz L_s165
L_b165:
    s_waitcnt vmcnt(5)
    buffer_load_dwordx4 a[20:23], v4, s[32:35], s72 offen offset:1024 nt
    v_mfma_f32_16x16x32_bf16 v[108:111], v[100:103], a[124:127], v[108:111]
    v_mfma_f32_16x16x32_bf16 v[112:115], v[104:107], a[124:127], v[112:115]
    v_perm_b32 v100, v180, v180, v8
    v_perm_b32 v101, v180, v180, v9
    v_perm_b32 v102, v180, v180, v10
    v_perm_b32 v103, v180, v180, v11
    v_perm_b32 v104, v180, v180, v12
    v_perm_b32 v105, v180, v180, v13
    v_perm_b32 v106, v180, v180, v14
    v_perm_b32 v107, v180, v180, v15
    s_cbranch_vccnz L_s166
L_b166:
    s_waitcnt vmcnt(5)
    buffer_load_dwordx4 a[24:27], v4, s[32:35], s72 offen offset:2048 nt
    s_cmp_lg_u32 s3, 3
    s_cbranch_scc1 L_ng7
    s_waitcnt lgkmcnt(0)
    s_cmp_eq_u32 s100, 0
    s_cselect_b32 s7, -3, 0
    s_cmp_eq_u32 s64, s6
    s_addc_u32 s7, s7, 0
    s_cmp_eq_u32 s65, s6
    s_addc_u32 s7, s7, 0
    s_cmp_eq_u32 s66, s6
    s_addc_u32 s7, s7, 0
    s_cmp_eq_u32 s67, s6
    s_addc_u32 s7, s7, 0
    s_cmp_eq_u32 s68, s6
    s_addc_u32 s7, s7, 0
    s_cmp_eq_u32 s69, s6
    s_addc_u32 s7, s7, 0
    s_cmp_eq_u32 s70, s6
    s_addc_u32 s7, s7, 0
    s_cmp_eq_u32 s71, s6
    s_addc_u32 s7, s7, 0
    s_cmp_lt_i32 s7, 4
    s_cselect_b32 s21, 1, 0
    v_mov_b32 v137, s21
    ds_write_b32 v243, v137
L_ng7:
    v_mfma_f32_16x16x32_bf16 v[108:111], v[100:103], a[0:3], v[108:111]
    v_mfma_f32_16x16x32_bf16 v[112:115], v[104:107], a[0:3], v[112:115]
    v_fma_f32 v125, v36, s75, -v120
    v_fma_f32 v126, v37, s75, -v121
    v_exp_f32 v125, v125
    v_exp_f32 v126, v126
    v_add_f32 v118, v118, v125
    v_add_f32 v119, v119, v126
    v_cvt_pk_bf16_f32 v127, v125, v126
    ds_write_b32 v5, v127 offset:512
    v_perm_b32 v100, v181, v181, v8
    v_perm_b32 v101, v181, v181, v9
    v_perm_b32 v102, v181, v181, v10
    v_perm_b32 v103, v181, v181, v11
    v_perm_b32 v104, v181, v181, v12
    v_perm_b32 v105, v181, v181, v13
    v_perm_b32 v106, v181, v181, v14
    v_perm_b32 v107, v181, v181, v15
    s_cbranch_vccnz L_s167
L_b167:
    s_waitcnt vmcnt(5)
    buffer_load_dwordx4 a[28:31], v4, s[32:35], s72 offen offset:3072 nt
    v_mfma_f32_16x16x32_bf16 v[108:111], v[100:103], a[4:7], v[108:111]
    v_mfma_f32_16x16x32_bf16 v[112:115], v[104:107], a[4:7], v[112:115]
    v_perm_b32 v100, v182, v182, v8
    v_perm_b32 v101, v182, v182, v9
    v_perm_b32 v102, v182, v182, v10
    v_perm_b32 v103, v182, v182, v11
    v_perm_b32 v104, v182, v182, v12
    v_perm_b32 v105, v182, v182, v13
    v_perm_b32 v106, v182, v182, v14
    v_perm_b32 v107, v182, v182, v15
    s_add_u32 s72, s101, 917504
    s_cbranch_vccnz L_s168
L_b168:
    s_waitcnt vmcnt(5)
    buffer_load_dwordx4 a[32:35], v4, s[32:35], s72 offen offset:0 nt
    ds_read_b32 v137, v243
    v_mfma_f32_16x16x32_bf16 v[108:111], v[100:103], a[8:11], v[108:111]
    v_mfma_f32_16x16x32_bf16 v[112:115], v[104:107], a[8:11], v[112:115]
    v_fma_f32 v125, v38, s75, -v120
    v_fma_f32 v126, v39, s75, -v121
    v_exp_f32 v125, v125
    v_exp_f32 v126, v126
    v_add_f32 v118, v118, v125
    v_add_f32 v119, v119, v126
    v_cvt_pk_bf16_f32 v127, v125, v126
    ds_write_b32 v5, v127 offset:768
    v_add_f32_dpp v118, v118, v118 row_ror:8 row_mask:0xf bank_mask:0xf
    v_add_f32_dpp v119, v119, v119 row_ror:8 row_mask:0xf bank_mask:0xf
    s_nop 0
    v_add_f32_dpp v118, v118, v118 row_ror:4 row_mask:0xf bank_mask:0xf
    v_add_f32_dpp v119, v119, v119 row_ror:4 row_mask:0xf bank_mask:0xf
    s_nop 0
    v_add_f32_dpp v118, v118, v118 row_ror:2 row_mask:0xf bank_mask:0xf
    v_add_f32_dpp v119, v119, v119 row_ror:2 row_mask:0xf bank_mask:0xf
    s_nop 0
    v_add_f32_dpp v118, v118, v118 row_ror:1 row_mask:0xf bank_mask:0xf
    v_add_f32_dpp v119, v119, v119 row_ror:1 row_mask:0xf bank_mask:0xf
    v_mov_b32 v125, v118
    v_mov_b32 v126, v119
    s_nop 0
    v_permlane32_swap_b32 v118, v125
    v_permlane32_swap_b32 v119, v126
    v_add_f32 v118, v118, v125
    v_add_f32 v119, v119, v126
    v_and_b32 v127, 16, v0
    s_lshl_b32 s7, s99, 2
    s_add_u32 s7, s7, s3
    s_lshl_b32 s7, s7, 5
    s_add_u32 s7, s7, 2097152
    v_bfi_b32 v220, s5, v116, v7
    v_bfi_b32 v221, s5, v117, v7
    v_bfi_b32 v222, s15, v7, v118
    v_bfi_b32 v223, s15, v7, v119
    s_mov_b64 exec, 0x10001
    s_cmp_eq_u32 s96, 0
    s_cbranch_scc1 L_ls4
    buffer_store_dwordx4 v[220:223], v127, s[36:39], s7 offen
L_le4:
    s_mov_b64 exec, -1
    s_cbranch_vccnz L_s169
L_b169:
    s_waitcnt vmcnt(6)
    buffer_load_dwordx4 a[36:39], v4, s[32:35], s72 offen offset:1024 nt
    s_waitcnt lgkmcnt(0)
    v_readfirstlane_b32 s21, v137
    s_and_b32 s21, s21, 3
    s_cmp_lg_u32 s21, 0
    s_cselect_b64 vcc, -1, 0
    v_perm_b32 v100, v183, v183, v8
    v_perm_b32 v101, v183, v183, v9
    v_perm_b32 v102, v183, v183, v10
    v_perm_b32 v103, v183, v183, v11
    v_perm_b32 v104, v183, v183, v12
    v_perm_b32 v105, v183, v183, v13
    v_perm_b32 v106, v183, v183, v14
    v_perm_b32 v107, v183, v183, v15
    v_mfma_f32_16x16x32_bf16 v[108:111], v[100:103], a[12:15], v[108:111]
    s_nop 0
    v_mfma_f32_16x16x32_bf16 v[112:115], v[104:107], a[12:15], v[112:115]
    v_perm_b32 v100, v184, v184, v8
    v_perm_b32 v101, v184, v184, v9
    v_perm_b32 v102, v184, v184, v10
    v_perm_b32 v103, v184, v184, v11
    v_perm_b32 v104, v184, v184, v12
    v_perm_b32 v105, v184, v184, v13
    v_perm_b32 v106, v184, v184, v14
    v_perm_b32 v107, v184, v184, v15
    s_cbranch_vccnz L_s170
L_b170:
    s_waitcnt vmcnt(6)
    buffer_load_dwordx4 a[40:43], v4, s[32:35], s72 offen offset:2048 nt
    v_mfma_f32_16x16x32_bf16 v[108:111], v[100:103], a[16:19], v[108:111]
    v_mfma_f32_16x16x32_bf16 v[112:115], v[104:107], a[16:19], v[112:115]
    ds_read_b128 v[156:159], v6 offset:2048
    ds_read_b128 v[160:163], v6 offset:2064
    ds_read_b128 v[164:167], v6 offset:2304
    ds_read_b128 v[168:171], v6 offset:2320
    v_perm_b32 v100, v185, v185, v8
    v_perm_b32 v101, v185, v185, v9
    v_perm_b32 v102, v185, v185, v10
    v_perm_b32 v103, v185, v185, v11
    v_perm_b32 v104, v185, v185, v12
    v_perm_b32 v105, v185, v185, v13
    v_perm_b32 v106, v185, v185, v14
    v_perm_b32 v107, v185, v185, v15
    s_cbranch_vccnz L_s171
L_b171:
    s_waitcnt vmcnt(6)
    buffer_load_dwordx4 a[44:47], v4, s[32:35], s72 offen offset:3072 nt
    v_mfma_f32_16x16x32_bf16 v[108:111], v[100:103], a[20:23], v[108:111]
    v_mfma_f32_16x16x32_bf16 v[112:115], v[104:107], a[20:23], v[112:115]
    v_perm_b32 v100, v186, v186, v8
    v_perm_b32 v101, v186, v186, v9
    v_perm_b32 v102, v186, v186, v10
    v_perm_b32 v103, v186, v186, v11
    v_perm_b32 v104, v186, v186, v12
    v_perm_b32 v105, v186, v186, v13
    v_perm_b32 v106, v186, v186, v14
    v_perm_b32 v107, v186, v186, v15
    s_add_u32 s72, s101, 933888
    s_cbranch_vccnz L_s172
L_b172:
    s_waitcnt vmcnt(6)
    buffer_load_dwordx4 a[48:51], v4, s[32:35], s72 offen offset:0 nt
    v_mfma_f32_16x16x32_bf16 v[108:111], v[100:103], a[24:27], v[108:111]
    v_mfma_f32_16x16x32_bf16 v[112:115], v[104:107], a[24:27], v[112:115]
    v_perm_b32 v100, v187, v187, v8
    v_perm_b32 v101, v187, v187, v9
    v_perm_b32 v102, v187, v187, v10
    v_perm_b32 v103, v187, v187, v11
    v_perm_b32 v104, v187, v187, v12
    v_perm_b32 v105, v187, v187, v13
    v_perm_b32 v106, v187, v187, v14
    v_perm_b32 v107, v187, v187, v15
    s_cbranch_vccnz L_s173
L_b173:
    s_waitcnt vmcnt(6)
    buffer_load_dwordx4 a[52:55], v4, s[32:35], s72 offen offset:1024 nt
    s_lshr_b32 s7, s2, 3
    s_and_b32 s7, s7, 15
    s_cmp_lg_u32 s7, 9
    s_cbranch_scc1 L_nr5
    s_getpc_b64 s[0:1]
L_rp5:
    s_add_u32 s0, s0, 1536
    s_addc_u32 s1, s1, 0
    global_load_dwordx4 v[228:231], v255, s[0:1]
L_nr5:
    v_mfma_f32_16x16x32_bf16 v[108:111], v[100:103], a[28:31], v[108:111]
    v_mfma_f32_16x16x32_bf16 v[112:115], v[104:107], a[28:31], v[112:115]
    s_waitcnt lgkmcnt(0)
    v_perm_b32 v100, v156, v156, v8
    v_perm_b32 v101, v156, v156, v9
    v_perm_b32 v102, v156, v156, v10
    v_perm_b32 v103, v156, v156, v11
    v_perm_b32 v104, v156, v156, v12
    v_perm_b32 v105, v156, v156, v13
    v_perm_b32 v106, v156, v156, v14
    v_perm_b32 v107, v156, v156, v15
    s_cbranch_vccnz L_s174
L_b174:
    s_waitcnt vmcnt(6)
    buffer_load_dwordx4 a[56:59], v4, s[32:35], s72 offen offset:2048 nt
    s_cmp_lg_u32 s3, 0
    s_cbranch_scc1 L_np8
    s_and_b32 s7, s2, 7
    s_mul_i32 s8, s7, 29
    s_lshr_b32 s22, s2, 3
    s_add_u32 s22, s22, s8
    s_add_u32 s22, s22, 24
    s_and_b32 s0, s22, 31
    s_and_b32 s22, s22, 31
    s_lshl_b32 s22, s22, 7
    s_add_u32 s22, s22, 425984
    s_load_dwordx8 s[64:71], s[26:27], s22 glc
    s_lshl_b32 s7, s7, 2
    s_xor_b32 s22, s22, 2048
    s_add_u32 s22, s22, s7
    s_atomic_swap s6, s[26:27], s22
L_np8:
    v_mfma_f32_16x16x32_bf16 v[108:111], v[100:103], a[32:35], v[108:111]
    v_mfma_f32_16x16x32_bf16 v[112:115], v[104:107], a[32:35], v[112:115]
    v_perm_b32 v100, v157, v157, v8
    v_perm_b32 v101, v157, v157, v9
    v_perm_b32 v102, v157, v157, v10
    v_perm_b32 v103, v157, v157, v11
    v_perm_b32 v104, v157, v157, v12
    v_perm_b32 v105, v157, v157, v13
    v_perm_b32 v106, v157, v157, v14
    v_perm_b32 v107, v157, v157, v15
    s_cbranch_vccnz L_s175
L_b175:
    s_waitcnt vmcnt(5)
    buffer_load_dwordx4 a[60:63], v4, s[32:35], s72 offen offset:3072 nt
    v_mfma_f32_16x16x32_bf16 v[108:111], v[100:103], a[36:39], v[108:111]
    v_mfma_f32_16x16x32_bf16 v[112:115], v[104:107], a[36:39], v[112:115]
    v_perm_b32 v100, v158, v158, v8
    v_perm_b32 v101, v158, v158, v9
    v_perm_b32 v102, v158, v158, v10
    v_perm_b32 v103, v158, v158, v11
    v_perm_b32 v104, v158, v158, v12
    v_perm_b32 v105, v158, v158, v13
    v_perm_b32 v106, v158, v158, v14
    v_perm_b32 v107, v158, v158, v15
    s_add_u32 s72, s101, 1048576
    s_cbranch_vccnz L_s176
L_b176:
    s_waitcnt vmcnt(5)
    buffer_load_dwordx4 a[64:67], v4, s[32:35], s72 offen offset:0 nt
    s_cmp_eq_u32 s73, 2
    s_cbranch_scc0 L_w20
    s_xor_b32 s7, s44, 256
    s_add_u32 s7, s7, 0
    s_add_u32 m0, s45, 16384
    s_nop 0
    buffer_load_dwordx4 v240, s[48:51], s7 offen nt lds
L_w20:
    v_mfma_f32_16x16x32_bf16 v[108:111], v[100:103], a[40:43], v[108:111]
    v_mfma_f32_16x16x32_bf16 v[112:115], v[104:107], a[40:43], v[112:115]
    v_perm_b32 v100, v159, v159, v8
    v_perm_b32 v101, v159, v159, v9
    v_perm_b32 v102, v159, v159, v10
    v_perm_b32 v103, v159, v159, v11
    v_perm_b32 v104, v159, v159, v12
    v_perm_b32 v105, v159, v159, v13
    v_perm_b32 v106, v159, v159, v14
    v_perm_b32 v107, v159, v159, v15
    s_cbranch_vccnz L_s177
L_b177:
    s_waitcnt vmcnt(5)
    buffer_load_dwordx4 a[68:71], v4, s[32:35], s72 offen offset:1024 nt
    v_mfma_f32_16x16x32_bf16 v[108:111], v[100:103], a[44:47], v[108:111]
    v_mfma_f32_16x16x32_bf16 v[112:115], v[104:107], a[44:47], v[112:115]
    v_perm_b32 v100, v160, v160, v8
    v_perm_b32 v101, v160, v160, v9
    v_perm_b32 v102, v160, v160, v10
    v_perm_b32 v103, v160, v160, v11
    v_perm_b32 v104, v160, v160, v12
    v_perm_b32 v105, v160, v160, v13
    v_perm_b32 v106, v160, v160, v14
    v_perm_b32 v107, v160, v160, v15
    s_cbranch_vccnz L_s178
L_b178:
    s_waitcnt vmcnt(5)
    buffer_load_dwordx4 a[72:75], v4, s[32:35], s72 offen offset:2048 nt
    v_mfma_f32_16x16x32_bf16 v[108:111], v[100:103], a[48:51], v[108:111]
    v_mfma_f32_16x16x32_bf16 v[112:115], v[104:107], a[48:51], v[112:115]
    v_perm_b32 v100, v161, v161, v8
    v_perm_b32 v101, v161, v161, v9
    v_perm_b32 v102, v161, v161, v10
    v_perm_b32 v103, v161, v161, v11
    v_perm_b32 v104, v161, v161, v12
    v_perm_b32 v105, v161, v161, v13
    v_perm_b32 v106, v161, v161, v14
    v_perm_b32 v107, v161, v161, v15
    s_cbranch_vccnz L_s179
L_b179:
    s_waitcnt vmcnt(5)
    buffer_load_dwordx4 a[76:79], v4, s[32:35], s72 offen offset:3072 nt
    v_mfma_f32_16x16x32_bf16 v[108:111], v[100:103], a[52:55], v[108:111]
    v_mfma_f32_16x16x32_bf16 v[112:115], v[104:107], a[52:55], v[112:115]
    v_perm_b32 v100, v162, v162, v8
    v_perm_b32 v101, v162, v162, v9
    v_perm_b32 v102, v162, v162, v10
    v_perm_b32 v103, v162, v162, v11
    v_perm_b32 v104, v162, v162, v12
    v_perm_b32 v105, v162, v162, v13
    v_perm_b32 v106, v162, v162, v14
    v_perm_b32 v107, v162, v162, v15
    s_add_u32 s72, s101, 1064960
    s_cbranch_vccnz L_s180
L_b180:
    s_waitcnt vmcnt(5)
    buffer_load_dwordx4 a[80:83], v4, s[32:35], s72 offen offset:0 nt
    v_mfma_f32_16x16x32_bf16 v[108:111], v[100:103], a[56:59], v[108:111]
    v_mfma_f32_16x16x32_bf16 v[112:115], v[104:107], a[56:59], v[112:115]
    v_perm_b32 v100, v163, v163, v8
    v_perm_b32 v101, v163, v163, v9
    v_perm_b32 v102, v163, v163, v10
    v_perm_b32 v103, v163, v163, v11
    v_perm_b32 v104, v163, v163, v12
    v_perm_b32 v105, v163, v163, v13
    v_perm_b32 v106, v163, v163, v14
    v_perm_b32 v107, v163, v163, v15
    s_cbranch_vccnz L_s181
L_b181:
    s_waitcnt vmcnt(5)
    buffer_load_dwordx4 a[84:87], v4, s[32:35], s72 offen offset:1024 nt
    v_mfma_f32_16x16x32_bf16 v[108:111], v[100:103], a[60:63], v[108:111]
    v_mfma_f32_16x16x32_bf16 v[112:115], v[104:107], a[60:63], v[112:115]
    v_perm_b32 v100, v164, v164, v8
    v_perm_b32 v101, v164, v164, v9
    v_perm_b32 v102, v164, v164, v10
    v_perm_b32 v103, v164, v164, v11
    v_perm_b32 v104, v164, v164, v12
    v_perm_b32 v105, v164, v164, v13
    v_perm_b32 v106, v164, v164, v14
    v_perm_b32 v107, v164, v164, v15
    s_cbranch_vccnz L_s182
L_b182:
    s_waitcnt vmcnt(5)
    buffer_load_dwordx4 a[88:91], v4, s[32:35], s72 offen offset:2048 nt
    s_cmp_lg_u32 s3, 0
    s_cbranch_scc1 L_ng8
    s_waitcnt lgkmcnt(0)
    s_cmp_eq_u32 s100, 0
    s_cselect_b32 s7, -3, 0
    s_cmp_eq_u32 s64, s6
    s_addc_u32 s7, s7, 0
    s_cmp_eq_u32 s65, s6
    s_addc_u32 s7, s7, 0
    s_cmp_eq_u32 s66, s6
    s_addc_u32 s7, s7, 0
    s_cmp_eq_u32 s67, s6
    s_addc_u32 s7, s7, 0
    s_cmp_eq_u32 s68, s6
    s_addc_u32 s7, s7, 0
    s_cmp_eq_u32 s69, s6
    s_addc_u32 s7, s7, 0
    s_cmp_eq_u32 s70, s6
    s_addc_u32 s7, s7, 0
    s_cmp_eq_u32 s71, s6
    s_addc_u32 s7, s7, 0
    s_cmp_lt_i32 s7, 4
    s_cselect_b32 s21, 1, 0
    v_mov_b32 v137, s21
    ds_write_b32 v243, v137
L_ng8:
    v_mfma_f32_16x16x32_bf16 v[108:111], v[100:103], a[64:67], v[108:111]
    v_mfma_f32_16x16x32_bf16 v[112:115], v[104:107], a[64:67], v[112:115]
    v_perm_b32 v100, v165, v165, v8
    v_perm_b32 v101, v165, v165, v9
    v_perm_b32 v102, v165, v165, v10
    v_perm_b32 v103, v165, v165, v11
    v_perm_b32 v104, v165, v165, v12
    v_perm_b32 v105, v165, v165, v13
    v_perm_b32 v106, v165, v165, v14
    v_perm_b32 v107, v165, v165, v15
    s_cbranch_vccnz L_s183
L_b183:
    s_waitcnt vmcnt(5)
    buffer_load_dwordx4 a[92:95], v4, s[32:35], s72 offen offset:3072 nt
    s_cmp_eq_u32 s73, 2
    s_cbranch_scc0 L_w21
    s_xor_b32 s7, s44, 256
    s_add_u32 s7, s7, 8192
    s_add_u32 m0, s45, 17408
    s_nop 0
    buffer_load_dwordx4 v244, s[48:51], s7 offen nt lds
L_w21:
    v_mfma_f32_16x16x32_bf16 v[108:111], v[100:103], a[68:71], v[108:111]
    v_mfma_f32_16x16x32_bf16 v[112:115], v[104:107], a[68:71], v[112:115]
    v_perm_b32 v100, v166, v166, v8
    v_perm_b32 v101, v166, v166, v9
    v_perm_b32 v102, v166, v166, v10
    v_perm_b32 v103, v166, v166, v11
    v_perm_b32 v104, v166, v166, v12
    v_perm_b32 v105, v166, v166, v13
    v_perm_b32 v106, v166, v166, v14
    v_perm_b32 v107, v166, v166, v15
    s_add_u32 s72, s101, 1179648
    s_cbranch_vccnz L_s184
L_b184:
    s_waitcnt vmcnt(5)
    buffer_load_dwordx4 a[96:99], v4, s[32:35], s72 offen offset:0 nt
    ds_read_b32 v137, v243
    v_mfma_f32_16x16x32_bf16 v[108:111], v[100:103], a[72:75], v[108:111]
    v_mfma_f32_16x16x32_bf16 v[112:115], v[104:107], a[72:75], v[112:115]
    v_perm_b32 v100, v167, v167, v8
    v_perm_b32 v101, v167, v167, v9
    v_perm_b32 v102, v167, v167, v10
    v_perm_b32 v103, v167, v167, v11
    v_perm_b32 v104, v167, v167, v12
    v_perm_b32 v105, v167, v167, v13
    v_perm_b32 v106, v167, v167, v14
    v_perm_b32 v107, v167, v167, v15
    s_cbranch_vccnz L_s185
L_b185:
    s_waitcnt vmcnt(5)
    buffer_load_dwordx4 a[100:103], v4, s[32:35], s72 offen offset:1024 nt
    s_waitcnt lgkmcnt(0)
    v_readfirstlane_b32 s21, v137
    s_and_b32 s21, s21, 3
    s_cmp_lg_u32 s21, 0
    s_cselect_b64 vcc, -1, 0
    v_mfma_f32_16x16x32_bf16 v[108:111], v[100:103], a[76:79], v[108:111]
    v_mfma_f32_16x16x32_bf16 v[112:115], v[104:107], a[76:79], v[112:115]
    v_perm_b32 v100, v168, v168, v8
    v_perm_b32 v101, v168, v168, v9
    v_perm_b32 v102, v168, v168, v10
    v_perm_b32 v103, v168, v168, v11
    v_perm_b32 v104, v168, v168, v12
    v_perm_b32 v105, v168, v168, v13
    v_perm_b32 v106, v168, v168, v14
    v_perm_b32 v107, v168, v168, v15
    s_cbranch_vccnz L_s186
L_b186:
    s_waitcnt vmcnt(5)
    buffer_load_dwordx4 a[104:107], v4, s[32:35], s72 offen offset:2048 nt
    v_mfma_f32_16x16x32_bf16 v[108:111], v[100:103], a[80:83], v[108:111]
    v_mfma_f32_16x16x32_bf16 v[112:115], v[104:107], a[80:83], v[112:115]
    ds_read_b128 v[172:175], v6 offset:2560
    ds_read_b128 v[176:179], v6 offset:2576
    ds_read_b128 v[180:183], v6 offset:2816
    ds_read_b128 v[184:187], v6 offset:2832
    v_perm_b32 v100, v169, v169, v8
    v_perm_b32 v101, v169, v169, v9
    v_perm_b32 v102, v169, v169, v10
    v_perm_b32 v103, v169, v169, v11
    v_perm_b32 v104, v169, v169, v12
    v_perm_b32 v105, v169, v169, v13
    v_perm_b32 v106, v169, v169, v14
    v_perm_b32 v107, v169, v169, v15
    s_cbranch_vccnz L_s187
L_b187:
    s_waitcnt vmcnt(5)
    buffer_load_dwordx4 a[108:111], v4, s[32:35], s72 offen offset:3072 nt
    v_mfma_f32_16x16x32_bf16 v[108:111], v[100:103], a[84:87], v[108:111]
    v_mfma_f32_16x16x32_bf16 v[112:115], v[104:107], a[84:87], v[112:115]
    v_perm_b32 v100, v170, v170, v8
    v_perm_b32 v101, v170, v170, v9
    v_perm_b32 v102, v170, v170, v10
    v_perm_b32 v103, v170, v170, v11
    v_perm_b32 v104, v170, v170, v12
    v_perm_b32 v105, v170, v170, v13
    v_perm_b32 v106, v170, v170, v14
    v_perm_b32 v107, v170, v170, v15
    s_add_u32 s72, s101, 1196032
    s_cbranch_vccnz L_s188
L_b188:
    s_waitcnt vmcnt(5)
    buffer_load_dwordx4 a[112:115], v4, s[32:35], s72 offen offset:0 nt
    v_mfma_f32_16x16x32_bf16 v[108:111], v[100:103], a[88:91], v[108:111]
    v_mfma_f32_16x16x32_bf16 v[112:115], v[104:107], a[88:91], v[112:115]
    v_perm_b32 v100, v171, v171, v8
    v_perm_b32 v101, v171, v171, v9
    v_perm_b32 v102, v171, v171, v10
    v_perm_b32 v103, v171, v171, v11
    v_perm_b32 v104, v171, v171, v12
    v_perm_b32 v105, v171, v171, v13
    v_perm_b32 v106, v171, v171, v14
    v_perm_b32 v107, v171, v171, v15
    s_cbranch_vccnz L_s189
L_b189:
    s_waitcnt vmcnt(5)
    buffer_load_dwordx4 a[116:119], v4, s[32:35], s72 offen offset:1024 nt
    v_mfma_f32_16x16x32_bf16 v[108:111], v[100:103], a[92:95], v[108:111]
    v_mfma_f32_16x16x32_bf16 v[112:115], v[104:107], a[92:95], v[112:115]
    s_waitcnt lgkmcnt(0)
    v_perm_b32 v100, v172, v172, v8
    v_perm_b32 v101, v172, v172, v9
    v_perm_b32 v102, v172, v172, v10
    v_perm_b32 v103, v172, v172, v11
    v_perm_b32 v104, v172, v172, v12
    v_perm_b32 v105, v172, v172, v13
    v_perm_b32 v106, v172, v172, v14
    v_perm_b32 v107, v172, v172, v15
    s_cbranch_vccnz L_s190
L_b190:
    s_waitcnt vmcnt(5)
    buffer_load_dwordx4 a[120:123], v4, s[32:35], s72 offen offset:2048 nt
    s_cmp_eq_u32 s73, 2
    s_cbranch_scc0 L_w22
    s_xor_b32 s7, s44, 256
    s_add_u32 s7, s7, 16384
    s_add_u32 m0, s45, 18432
    s_nop 0
    buffer_load_dwordx4 v240, s[48:51], s7 offen nt lds
L_w22:
    s_cmp_lg_u32 s3, 1
    s_cbranch_scc1 L_np9
    s_and_b32 s7, s2, 7
    s_mul_i32 s8, s7, 0
    s_lshr_b32 s22, s2, 3
    s_add_u32 s22, s22, s8
    s_add_u32 s22, s22, 3
    s_and_b32 s0, s22, 31
    s_and_b32 s22, s22, 31
    s_lshl_b32 s22, s22, 7
    s_add_u32 s22, s22, 430080
    s_load_dwordx8 s[64:71], s[26:27], s22 glc
    s_lshl_b32 s7, s7, 2
    s_xor_b32 s22, s22, 2048
    s_add_u32 s22, s22, s7
    s_atomic_swap s6, s[26:27], s22
L_np9:
    v_mfma_f32_16x16x32_bf16 v[108:111], v[100:103], a[96:99], v[108:111]
    v_mfma_f32_16x16x32_bf16 v[112:115], v[104:107], a[96:99], v[112:115]
    v_perm_b32 v100, v173, v173, v8
    v_perm_b32 v101, v173, v173, v9
    v_perm_b32 v102, v173, v173, v10
    v_perm_b32 v103, v173, v173, v11
    v_perm_b32 v104, v173, v173, v12
    v_perm_b32 v105, v173, v173, v13
    v_perm_b32 v106, v173, v173, v14
    v_perm_b32 v107, v173, v173, v15
    s_cbranch_vccnz L_s191
L_b191:
    s_waitcnt vmcnt(5)
    buffer_load_dwordx4 a[124:127], v4, s[32:35], s72 offen offset:3072 nt
    v_mfma_f32_16x16x32_bf16 v[108:111], v[100:103], a[100:103], v[108:111]
    v_mfma_f32_16x16x32_bf16 v[112:115], v[104:107], a[100:103], v[112:115]
    v_perm_b32 v100, v174, v174, v8
    v_perm_b32 v101, v174, v174, v9
    v_perm_b32 v102, v174, v174, v10
    v_perm_b32 v103, v174, v174, v11
    v_perm_b32 v104, v174, v174, v12
    v_perm_b32 v105, v174, v174, v13
    v_perm_b32 v106, v174, v174, v14
    v_perm_b32 v107, v174, v174, v15
    s_add_u32 s72, s101, 1310720
    s_cbranch_vccnz L_s192
L_b192:
    s_waitcnt vmcnt(5)
    buffer_load_dwordx4 a[0:3], v4, s[32:35], s72 offen offset:0 nt
    v_mfma_f32_16x16x32_bf16 v[108:111], v[100:103], a[104:107], v[108:111]
    v_mfma_f32_16x16x32_bf16 v[112:115], v[104:107], a[104:107], v[112:115]
    v_perm_b32 v100, v175, v175, v8
    v_perm_b32 v101, v175, v175, v9
    v_perm_b32 v102, v175, v175, v10
    v_perm_b32 v103, v175, v175, v11
    v_perm_b32 v104, v175, v175, v12
    v_perm_b32 v105, v175, v175, v13
    v_perm_b32 v106, v175, v175, v14
    v_perm_b32 v107, v175, v175, v15
    s_cbranch_vccnz L_s193
L_b193:
    s_waitcnt vmcnt(5)
    buffer_load_dwordx4 a[4:7], v4, s[32:35], s72 offen offset:1024 nt
    v_mfma_f32_16x16x32_bf16 v[108:111], v[100:103], a[108:111], v[108:111]
    v_mfma_f32_16x16x32_bf16 v[112:115], v[104:107], a[108:111], v[112:115]
    v_perm_b32 v100, v176, v176, v8
    v_perm_b32 v101, v176, v176, v9
    v_perm_b32 v102, v176, v176, v10
    v_perm_b32 v103, v176, v176, v11
    v_perm_b32 v104, v176, v176, v12
    v_perm_b32 v105, v176, v176, v13
    v_perm_b32 v106, v176, v176, v14
    v_perm_b32 v107, v176, v176, v15
    s_cbranch_vccnz L_s194
L_b194:
    s_waitcnt vmcnt(5)
    buffer_load_dwordx4 a[8:11], v4, s[32:35], s72 offen offset:2048 nt
    v_mfma_f32_16x16x32_bf16 v[108:111], v[100:103], a[112:115], v[108:111]
    v_mfma_f32_16x16x32_bf16 v[112:115], v[104:107], a[112:115], v[112:115]
    v_perm_b32 v100, v177, v177, v8
    v_perm_b32 v101, v177, v177, v9
    v_perm_b32 v102, v177, v177, v10
    v_perm_b32 v103, v177, v177, v11
    v_perm_b32 v104, v177, v177, v12
    v_perm_b32 v105, v177, v177, v13
    v_perm_b32 v106, v177, v177, v14
    v_perm_b32 v107, v177, v177, v15
    s_cbranch_vccnz L_s195
L_b195:
    s_waitcnt vmcnt(5)
    buffer_load_dwordx4 a[12:15], v4, s[32:35], s72 offen offset:3072 nt
    v_mfma_f32_16x16x32_bf16 v[108:111], v[100:103], a[116:119], v[108:111]
    v_mfma_f32_16x16x32_bf16 v[112:115], v[104:107], a[116:119], v[112:115]
    v_perm_b32 v100, v178, v178, v8
    v_perm_b32 v101, v178, v178, v9
    v_perm_b32 v102, v178, v178, v10
    v_perm_b32 v103, v178, v178, v11
    v_perm_b32 v104, v178, v178, v12
    v_perm_b32 v105, v178, v178, v13
    v_perm_b32 v106, v178, v178, v14
    v_perm_b32 v107, v178, v178, v15
    s_add_u32 s72, s101, 1327104
    s_cbranch_vccnz L_s196
L_b196:
    s_waitcnt vmcnt(5)
    buffer_load_dwordx4 a[16:19], v4, s[32:35], s72 offen offset:0 nt
    v_mfma_f32_16x16x32_bf16 v[108:111], v[100:103], a[120:123], v[108:111]
    v_mfma_f32_16x16x32_bf16 v[112:115], v[104:107], a[120:123], v[112:115]
    v_perm_b32 v100, v179, v179, v8
    v_perm_b32 v101, v179, v179, v9
    v_perm_b32 v102, v179, v179, v10
    v_perm_b32 v103, v179, v179, v11
    v_perm_b32 v104, v179, v179, v12
    v_perm_b32 v105, v179, v179, v13
    v_perm_b32 v106, v179, v179, v14
    v_perm_b32 v107, v179, v179, v15
    s_cbranch_vccnz L_s197
L_b197:
    s_waitcnt vmcnt(5)
    buffer_load_dwordx4 a[20:23], v4, s[32:35], s72 offen offset:1024 nt
    s_cmp_eq_u32 s73, 2
    s_cbranch_scc0 L_w23
    s_xor_b32 s7, s44, 256
    s_add_u32 s7, s7, 24576
    s_add_u32 m0, s45, 19456
    s_nop 0
    buffer_load_dwordx4 v244, s[48:51], s7 offen nt lds
L_w23:
    v_mfma_f32_16x16x32_bf16 v[108:111], v[100:103], a[124:127], v[108:111]
    v_mfma_f32_16x16x32_bf16 v[112:115], v[104:107], a[124:127], v[112:115]
    v_perm_b32 v100, v180, v180, v8
    v_perm_b32 v101, v180, v180, v9
    v_perm_b32 v102, v180, v180, v10
    v_perm_b32 v103, v180, v180, v11
    v_perm_b32 v104, v180, v180, v12
    v_perm_b32 v105, v180, v180, v13
    v_perm_b32 v106, v180, v180, v14
    v_perm_b32 v107, v180, v180, v15
    s_cbranch_vccnz L_s198
L_b198:
    s_waitcnt vmcnt(5)
    buffer_load_dwordx4 a[24:27], v4, s[32:35], s72 offen offset:2048 nt
    s_cmp_lg_u32 s3, 1
    s_cbranch_scc1 L_ng9
    s_waitcnt lgkmcnt(0)
    s_cmp_eq_u32 s100, 0
    s_cselect_b32 s7, -3, 0
    s_cmp_eq_u32 s64, s6
    s_addc_u32 s7, s7, 0
    s_cmp_eq_u32 s65, s6
    s_addc_u32 s7, s7, 0
    s_cmp_eq_u32 s66, s6
    s_addc_u32 s7, s7, 0
    s_cmp_eq_u32 s67, s6
    s_addc_u32 s7, s7, 0
    s_cmp_eq_u32 s68, s6
    s_addc_u32 s7, s7, 0
    s_cmp_eq_u32 s69, s6
    s_addc_u32 s7, s7, 0
    s_cmp_eq_u32 s70, s6
    s_addc_u32 s7, s7, 0
    s_cmp_eq_u32 s71, s6
    s_addc_u32 s7, s7, 0
    s_cmp_lt_i32 s7, 4
    s_cselect_b32 s21, 1, 0
    v_mov_b32 v137, s21
    ds_write_b32 v243, v137
L_ng9:
    v_mfma_f32_16x16x32_bf16 v[108:111], v[100:103], a[0:3], v[108:111]
    v_mfma_f32_16x16x32_bf16 v[112:115], v[104:107], a[0:3], v[112:115]
    v_perm_b32 v100, v181, v181, v8
    v_perm_b32 v101, v181, v181, v9
    v_perm_b32 v102, v181, v181, v10
    v_perm_b32 v103, v181, v181, v11
    v_perm_b32 v104, v181, v181, v12
    v_perm_b32 v105, v181, v181, v13
    v_perm_b32 v106, v181, v181, v14
    v_perm_b32 v107, v181, v181, v15
    s_cbranch_vccnz L_s199
L_b199:
    s_waitcnt vmcnt(5)
    buffer_load_dwordx4 a[28:31], v4, s[32:35], s72 offen offset:3072 nt
    v_mfma_f32_16x16x32_bf16 v[108:111], v[100:103], a[4:7], v[108:111]
    v_mfma_f32_16x16x32_bf16 v[112:115], v[104:107], a[4:7], v[112:115]
    v_perm_b32 v100, v182, v182, v8
    v_perm_b32 v101, v182, v182, v9
    v_perm_b32 v102, v182, v182, v10
    v_perm_b32 v103, v182, v182, v11
    v_perm_b32 v104, v182, v182, v12
    v_perm_b32 v105, v182, v182, v13
    v_perm_b32 v106, v182, v182, v14
    v_perm_b32 v107, v182, v182, v15
    s_add_u32 s72, s101, 1441792
    s_cbranch_vccnz L_s200
L_b200:
    s_waitcnt vmcnt(5)
    buffer_load_dwordx4 a[32:35], v4, s[32:35], s72 offen offset:0 nt
    ds_read_b32 v137, v243
    v_mfma_f32_16x16x32_bf16 v[108:111], v[100:103], a[8:11], v[108:111]
    v_mfma_f32_16x16x32_bf16 v[112:115], v[104:107], a[8:11], v[112:115]
    v_perm_b32 v100, v183, v183, v8
    v_perm_b32 v101, v183, v183, v9
    v_perm_b32 v102, v183, v183, v10
    v_perm_b32 v103, v183, v183, v11
    v_perm_b32 v104, v183, v183, v12
    v_perm_b32 v105, v183, v183, v13
    v_perm_b32 v106, v183, v183, v14
    v_perm_b32 v107, v183, v183, v15
    s_cbranch_vccnz L_s201
L_b201:
    s_waitcnt vmcnt(5)
    buffer_load_dwordx4 a[36:39], v4, s[32:35], s72 offen offset:1024 nt
    s_lshr_b32 s7, s2, 3
    s_and_b32 s7, s7, 15
    s_cmp_lg_u32 s7, 14
    s_cbranch_scc1 L_nr6
    s_getpc_b64 s[0:1]
L_rp6:
    s_add_u32 s0, s0, 1536
    s_addc_u32 s1, s1, 0
    global_load_dwordx4 v[228:231], v255, s[0:1]
L_nr6:
    s_waitcnt lgkmcnt(0)
    v_readfirstlane_b32 s21, v137
    s_and_b32 s21, s21, 3
    s_cmp_lg_u32 s21, 0
    s_cselect_b64 vcc, -1, 0
    v_mfma_f32_16x16x32_bf16 v[108:111], v[100:103], a[12:15], v[108:111]
    v_mfma_f32_16x16x32_bf16 v[112:115], v[104:107], a[12:15], v[112:115]
    v_perm_b32 v100, v184, v184, v8
    v_perm_b32 v101, v184, v184, v9
    v_perm_b32 v102, v184, v184, v10
    v_perm_b32 v103, v184, v184, v11
    v_perm_b32 v104, v184, v184, v12
    v_perm_b32 v105, v184, v184, v13
    v_perm_b32 v106, v184, v184, v14
    v_perm_b32 v107, v184, v184, v15
    s_cbranch_vccnz L_s202
L_b202:
    s_waitcnt vmcnt(5)
    buffer_load_dwordx4 a[40:43], v4, s[32:35], s72 offen offset:2048 nt
    v_mfma_f32_16x16x32_bf16 v[108:111], v[100:103], a[16:19], v[108:111]
    v_mfma_f32_16x16x32_bf16 v[112:115], v[104:107], a[16:19], v[112:115]
    ds_read_b128 v[156:159], v6 offset:3072
    ds_read_b128 v[160:163], v6 offset:3088
    ds_read_b128 v[164:167], v6 offset:3328
    ds_read_b128 v[168:171], v6 offset:3344
    v_perm_b32 v100, v185, v185, v8
    v_perm_b32 v101, v185, v185, v9
    v_perm_b32 v102, v185, v185, v10
    v_perm_b32 v103, v185, v185, v11
    v_perm_b32 v104, v185, v185, v12
    v_perm_b32 v105, v185, v185, v13
    v_perm_b32 v106, v185, v185, v14
    v_perm_b32 v107, v185, v185, v15
    s_cbranch_vccnz L_s203
L_b203:
    s_waitcnt vmcnt(5)
    buffer_load_dwordx4 a[44:47], v4, s[32:35], s72 offen offset:3072 nt
    v_mfma_f32_16x16x32_bf16 v[108:111], v[100:103], a[20:23], v[108:111]
    v_mfma_f32_16x16x32_bf16 v[112:115], v[104:107], a[20:23], v[112:115]
    v_perm_b32 v100, v186, v186, v8
    v_perm_b32 v101, v186, v186, v9
    v_perm_b32 v102, v186, v186, v10
    v_perm_b32 v103, v186, v186, v11
    v_perm_b32 v104, v186, v186, v12
    v_perm_b32 v105, v186, v186, v13
    v_perm_b32 v106, v186, v186, v14
    v_perm_b32 v107, v186, v186, v15
    s_add_u32 s72, s101, 1458176
    s_cbranch_vccnz L_s204
L_b204:
    s_waitcnt vmcnt(5)
    buffer_load_dwordx4 a[48:51], v4, s[32:35], s72 offen offset:0 nt
    v_mfma_f32_16x16x32_bf16 v[108:111], v[100:103], a[24:27], v[108:111]
    v_mfma_f32_16x16x32_bf16 v[112:115], v[104:107], a[24:27], v[112:115]
    v_perm_b32 v100, v187, v187, v8
    v_perm_b32 v101, v187, v187, v9
    v_perm_b32 v102, v187, v187, v10
    v_perm_b32 v103, v187, v187, v11
    v_perm_b32 v104, v187, v187, v12
    v_perm_b32 v105, v187, v187, v13
    v_perm_b32 v106, v187, v187, v14
    v_perm_b32 v107, v187, v187, v15
    s_cbranch_vccnz L_s205
L_b205:
    s_waitcnt vmcnt(5)
    buffer_load_dwordx4 a[52:55], v4, s[32:35], s72 offen offset:1024 nt
    v_mfma_f32_16x16x32_bf16 v[108:111], v[100:103], a[28:31], v[108:111]
    v_mfma_f32_16x16x32_bf16 v[112:115], v[104:107], a[28:31], v[112:115]
    s_waitcnt lgkmcnt(0)
    v_perm_b32 v100, v156, v156, v8
    v_perm_b32 v101, v156, v156, v9
    v_perm_b32 v102, v156, v156, v10
    v_perm_b32 v103, v156, v156, v11
    v_perm_b32 v104, v156, v156, v12
    v_perm_b32 v105, v156, v156, v13
    v_perm_b32 v106, v156, v156, v14
    v_perm_b32 v107, v156, v156, v15
    s_cbranch_vccnz L_s206
L_b206:
    s_waitcnt vmcnt(5)
    buffer_load_dwordx4 a[56:59], v4, s[32:35], s72 offen offset:2048 nt
    s_cmp_lg_u32 s3, 2
    s_cbranch_scc1 L_np10
    s_and_b32 s7, s2, 7
    s_mul_i32 s8, s7, 3
    s_lshr_b32 s22, s2, 3
    s_add_u32 s22, s22, s8
    s_add_u32 s22, s22, 14
    s_and_b32 s0, s22, 31
    s_and_b32 s22, s22, 31
    s_lshl_b32 s22, s22, 7
    s_add_u32 s22, s22, 434176
    s_load_dwordx8 s[64:71], s[26:27], s22 glc
    s_lshl_b32 s7, s7, 2
    s_xor_b32 s22, s22, 2048
    s_add_u32 s22, s22, s7
    s_atomic_swap s6, s[26:27], s22
L_np10:
    v_mfma_f32_16x16x32_bf16 v[108:111], v[100:103], a[32:35], v[108:111]
    v_mfma_f32_16x16x32_bf16 v[112:115], v[104:107], a[32:35], v[112:115]
    v_perm_b32 v100, v157, v157, v8
    v_perm_b32 v101, v157, v157, v9
    v_perm_b32 v102, v157, v157, v10
    v_perm_b32 v103, v157, v157, v11
    v_perm_b32 v104, v157, v157, v12
    v_perm_b32 v105, v157, v157, v13
    v_perm_b32 v106, v157, v157, v14
    v_perm_b32 v107, v157, v157, v15
    s_cbranch_vccnz L_s207
L_b207:
    s_waitcnt vmcnt(5)
    buffer_load_dwordx4 a[60:63], v4, s[32:35], s72 offen offset:3072 nt
    v_mfma_f32_16x16x32_bf16 v[108:111], v[100:103], a[36:39], v[108:111]
    v_mfma_f32_16x16x32_bf16 v[112:115], v[104:107], a[36:39], v[112:115]
    v_perm_b32 v100, v158, v158, v8
    v_perm_b32 v101, v158, v158, v9
    v_perm_b32 v102, v158, v158, v10
    v_perm_b32 v103, v158, v158, v11
    v_perm_b32 v104, v158, v158, v12
    v_perm_b32 v105, v158, v158, v13
    v_perm_b32 v106, v158, v158, v14
    v_perm_b32 v107, v158, v158, v15
    s_add_u32 s72, s101, 1572864
    s_cbranch_vccnz L_s208
L_b208:
    s_waitcnt vmcnt(5)
    buffer_load_dwordx4 a[64:67], v4, s[32:35], s72 offen offset:0 nt
    v_mfma_f32_16x16x32_bf16 v[108:111], v[100:103], a[40:43], v[108:111]
    v_mfma_f32_16x16x32_bf16 v[112:115], v[104:107], a[40:43], v[112:115]
    v_perm_b32 v100, v159, v159, v8
    v_perm_b32 v101, v159, v159, v9
    v_perm_b32 v102, v159, v159, v10
    v_perm_b32 v103, v159, v159, v11
    v_perm_b32 v104, v159, v159, v12
    v_perm_b32 v105, v159, v159, v13
    v_perm_b32 v106, v159, v159, v14
    v_perm_b32 v107, v159, v159, v15
    s_cbranch_vccnz L_s209
L_b209:
    s_waitcnt vmcnt(5)
    buffer_load_dwordx4 a[68:71], v4, s[32:35], s72 offen offset:1024 nt
    v_mfma_f32_16x16x32_bf16 v[108:111], v[100:103], a[44:47], v[108:111]
    v_mfma_f32_16x16x32_bf16 v[112:115], v[104:107], a[44:47], v[112:115]
    v_perm_b32 v100, v160, v160, v8
    v_perm_b32 v101, v160, v160, v9
    v_perm_b32 v102, v160, v160, v10
    v_perm_b32 v103, v160, v160, v11
    v_perm_b32 v104, v160, v160, v12
    v_perm_b32 v105, v160, v160, v13
    v_perm_b32 v106, v160, v160, v14
    v_perm_b32 v107, v160, v160, v15
    s_cbranch_vccnz L_s210
L_b210:
    s_waitcnt vmcnt(5)
    buffer_load_dwordx4 a[72:75], v4, s[32:35], s72 offen offset:2048 nt
    v_mfma_f32_16x16x32_bf16 v[108:111], v[100:103], a[48:51], v[108:111]
    v_mfma_f32_16x16x32_bf16 v[112:115], v[104:107], a[48:51], v[112:115]
    v_perm_b32 v100, v161, v161, v8
    v_perm_b32 v101, v161, v161, v9
    v_perm_b32 v102, v161, v161, v10
    v_perm_b32 v103, v161, v161, v11
    v_perm_b32 v104, v161, v161, v12
    v_perm_b32 v105, v161, v161, v13
    v_perm_b32 v106, v161, v161, v14
    v_perm_b32 v107, v161, v161, v15
    s_cbranch_vccnz L_s211
L_b211:
    s_waitcnt vmcnt(5)
    buffer_load_dwordx4 a[76:79], v4, s[32:35], s72 offen offset:3072 nt
    v_mfma_f32_16x16x32_bf16 v[108:111], v[100:103], a[52:55], v[108:111]
    v_mfma_f32_16x16x32_bf16 v[112:115], v[104:107], a[52:55], v[112:115]
    v_perm_b32 v100, v162, v162, v8
    v_perm_b32 v101, v162, v162, v9
    v_perm_b32 v102, v162, v162, v10
    v_perm_b32 v103, v162, v162, v11
    v_perm_b32 v104, v162, v162, v12
    v_perm_b32 v105, v162, v162, v13
    v_perm_b32 v106, v162, v162, v14
    v_perm_b32 v107, v162, v162, v15
    s_add_u32 s72, s101, 1589248
    s_cbranch_vccnz L_s212
L_b212:
    s_waitcnt vmcnt(5)
    buffer_load_dwordx4 a[80:83], v4, s[32:35], s72 offen offset:0 nt
    v_mfma_f32_16x16x32_bf16 v[108:111], v[100:103], a[56:59], v[108:111]
    v_mfma_f32_16x16x32_bf16 v[112:115], v[104:107], a[56:59], v[112:115]
    v_perm_b32 v100, v163, v163, v8
    v_perm_b32 v101, v163, v163, v9
    v_perm_b32 v102, v163, v163, v10
    v_perm_b32 v103, v163, v163, v11
    v_perm_b32 v104, v163, v163, v12
    v_perm_b32 v105, v163, v163, v13
    v_perm_b32 v106, v163, v163, v14
    v_perm_b32 v107, v163, v163, v15
    s_cbranch_vccnz L_s213
L_b213:
    s_waitcnt vmcnt(5)
    buffer_load_dwordx4 a[84:87], v4, s[32:35], s72 offen offset:1024 nt
    v_mfma_f32_16x16x32_bf16 v[108:111], v[100:103], a[60:63], v[108:111]
    v_mfma_f32_16x16x32_bf16 v[112:115], v[104:107], a[60:63], v[112:115]
    v_perm_b32 v100, v164, v164, v8
    v_perm_b32 v101, v164, v164, v9
    v_perm_b32 v102, v164, v164, v10
    v_perm_b32 v103, v164, v164, v11
    v_perm_b32 v104, v164, v164, v12
    v_perm_b32 v105, v164, v164, v13
    v_perm_b32 v106, v164, v164, v14
    v_perm_b32 v107, v164, v164, v15
    s_cbranch_vccnz L_s214
L_b214:
    s_waitcnt vmcnt(5)
    buffer_load_dwordx4 a[88:91], v4, s[32:35], s72 offen offset:2048 nt
    v_and_b32 v139, 16, v0
    v_lshl_or_b32 v139, v141, 5, v139
    s_lshr_b32 s9, s99, 2
    s_lshl_b32 s9, s9, 9
    s_add_u32 s9, s9, 2097152
    buffer_load_dwordx4 v[188:191], v139, s[36:39], s9 offen sc1
    s_cmp_lg_u32 s3, 2
    s_cbranch_scc1 L_ng10
    s_waitcnt lgkmcnt(0)
    s_cmp_eq_u32 s100, 0
    s_cselect_b32 s7, -3, 0
    s_cmp_eq_u32 s64, s6
    s_addc_u32 s7, s7, 0
    s_cmp_eq_u32 s65, s6
    s_addc_u32 s7, s7, 0
    s_cmp_eq_u32 s66, s6
    s_addc_u32 s7, s7, 0
    s_cmp_eq_u32 s67, s6
    s_addc_u32 s7, s7, 0
    s_cmp_eq_u32 s68, s6
    s_addc_u32 s7, s7, 0
    s_cmp_eq_u32 s69, s6
    s_addc_u32 s7, s7, 0
    s_cmp_eq_u32 s70, s6
    s_addc_u32 s7, s7, 0
    s_cmp_eq_u32 s71, s6
    s_addc_u32 s7, s7, 0
    s_cmp_lt_i32 s7, 4
    s_cselect_b32 s21, 1, 0
    v_mov_b32 v137, s21
    ds_write_b32 v243, v137
L_ng10:
    v_mfma_f32_16x16x32_bf16 v[108:111], v[100:103], a[64:67], v[108:111]
    v_mfma_f32_16x16x32_bf16 v[112:115], v[104:107], a[64:67], v[112:115]
    v_perm_b32 v100, v165, v165, v8
    v_perm_b32 v101, v165, v165, v9
    v_perm_b32 v102, v165, v165, v10
    v_perm_b32 v103, v165, v165, v11
    v_perm_b32 v104, v165, v165, v12
    v_perm_b32 v105, v165, v165, v13
    v_perm_b32 v106, v165, v165, v14
    v_perm_b32 v107, v165, v165, v15
    s_cbranch_vccnz L_s215
L_b215:
    s_waitcnt vmcnt(6)
    buffer_load_dwordx4 a[92:95], v4, s[32:35], s72 offen offset:3072 nt
    v_mfma_f32_16x16x32_bf16 v[108:111], v[100:103], a[68:71], v[108:111]
    v_mfma_f32_16x16x32_bf16 v[112:115], v[104:107], a[68:71], v[112:115]
    v_perm_b32 v100, v166, v166, v8
    v_perm_b32 v101, v166, v166, v9
    v_perm_b32 v102, v166, v166, v10
    v_perm_b32 v103, v166, v166, v11
    v_perm_b32 v104, v166, v166, v12
    v_perm_b32 v105, v166, v166, v13
    v_perm_b32 v106, v166, v166, v14
    v_perm_b32 v107, v166, v166, v15
    s_add_u32 s72, s101, 1703936
    s_cbranch_vccnz L_s216
L_b216:
    s_waitcnt vmcnt(6)
    buffer_load_dwordx4 a[96:99], v4, s[32:35], s72 offen offset:0 nt
    ds_read_b32 v137, v243
    v_mfma_f32_16x16x32_bf16 v[108:111], v[100:103], a[72:75], v[108:111]
    v_mfma_f32_16x16x32_bf16 v[112:115], v[104:107], a[72:75], v[112:115]
    v_perm_b32 v100, v167, v167, v8
    v_perm_b32 v101, v167, v167, v9
    v_perm_b32 v102, v167, v167, v10
    v_perm_b32 v103, v167, v167, v11
    v_perm_b32 v104, v167, v167, v12
    v_perm_b32 v105, v167, v167, v13
    v_perm_b32 v106, v167, v167, v14
    v_perm_b32 v107, v167, v167, v15
    s_cbranch_vccnz L_s217
L_b217:
    s_waitcnt vmcnt(6)
    buffer_load_dwordx4 a[100:103], v4, s[32:35], s72 offen offset:1024 nt
    s_waitcnt lgkmcnt(0)
    v_readfirstlane_b32 s21, v137
    s_and_b32 s21, s21, 3
    s_cmp_lg_u32 s21, 0
    s_cselect_b64 vcc, -1, 0
    v_mfma_f32_16x16x32_bf16 v[108:111], v[100:103], a[76:79], v[108:111]
    v_mfma_f32_16x16x32_bf16 v[112:115], v[104:107], a[76:79], v[112:115]
    v_perm_b32 v100, v168, v168, v8
    v_perm_b32 v101, v168, v168, v9
    v_perm_b32 v102, v168, v168, v10
    v_perm_b32 v103, v168, v168, v11
    v_perm_b32 v104, v168, v168, v12
    v_perm_b32 v105, v168, v168, v13
    v_perm_b32 v106, v168, v168, v14
    v_perm_b32 v107, v168, v168, v15
    s_cbranch_vccnz L_s218
L_b218:
    s_waitcnt vmcnt(6)
    buffer_load_dwordx4 a[104:107], v4, s[32:35], s72 offen offset:2048 nt
    v_mfma_f32_16x16x32_bf16 v[108:111], v[100:103], a[80:83], v[108:111]
    v_mfma_f32_16x16x32_bf16 v[112:115], v[104:107], a[80:83], v[112:115]
    ds_read_b128 v[172:175], v6 offset:3584
    ds_read_b128 v[176:179], v6 offset:3600
    ds_read_b128 v[180:183], v6 offset:3840
    ds_read_b128 v[184:187], v6 offset:3856
    v_perm_b32 v100, v169, v169, v8
    v_perm_b32 v101, v169, v169, v9
    v_perm_b32 v102, v169, v169, v10
    v_perm_b32 v103, v169, v169, v11
    v_perm_b32 v104, v169, v169, v12
    v_perm_b32 v105, v169, v169, v13
    v_perm_b32 v106, v169, v169, v14
    v_perm_b32 v107, v169, v169, v15
    s_cbranch_vccnz L_s219
L_b219:
    s_waitcnt vmcnt(6)
    buffer_load_dwordx4 a[108:111], v4, s[32:35], s72 offen offset:3072 nt
    v_mfma_f32_16x16x32_bf16 v[108:111], v[100:103], a[84:87], v[108:111]
    v_mfma_f32_16x16x32_bf16 v[112:115], v[104:107], a[84:87], v[112:115]
    v_perm_b32 v100, v170, v170, v8
    v_perm_b32 v101, v170, v170, v9
    v_perm_b32 v102, v170, v170, v10
    v_perm_b32 v103, v170, v170, v11
    v_perm_b32 v104, v170, v170, v12
    v_perm_b32 v105, v170, v170, v13
    v_perm_b32 v106, v170, v170, v14
    v_perm_b32 v107, v170, v170, v15
    s_add_u32 s72, s101, 1720320
    s_cbranch_vccnz L_s220
L_b220:
    s_waitcnt vmcnt(6)
    buffer_load_dwordx4 a[112:115], v4, s[32:35], s72 offen offset:0 nt
    v_mfma_f32_16x16x32_bf16 v[108:111], v[100:103], a[88:91], v[108:111]
    v_mfma_f32_16x16x32_bf16 v[112:115], v[104:107], a[88:91], v[112:115]
    v_perm_b32 v100, v171, v171, v8
    v_perm_b32 v101, v171, v171, v9
    v_perm_b32 v102, v171, v171, v10
    v_perm_b32 v103, v171, v171, v11
    v_perm_b32 v104, v171, v171, v12
    v_perm_b32 v105, v171, v171, v13
    v_perm_b32 v106, v171, v171, v14
    v_perm_b32 v107, v171, v171, v15
    s_cbranch_vccnz L_s221
L_b221:
    s_waitcnt vmcnt(5)
    buffer_load_dwordx4 a[116:119], v4, s[32:35], s72 offen offset:1024 nt
    v_mfma_f32_16x16x32_bf16 v[108:111], v[100:103], a[92:95], v[108:111]
    v_mfma_f32_16x16x32_bf16 v[112:115], v[104:107], a[92:95], v[112:115]
    s_waitcnt lgkmcnt(0)
    v_perm_b32 v100, v172, v172, v8
    v_perm_b32 v101, v172, v172, v9
    v_perm_b32 v102, v172, v172, v10
    v_perm_b32 v103, v172, v172, v11
    v_perm_b32 v104, v172, v172, v12
    v_perm_b32 v105, v172, v172, v13
    v_perm_b32 v106, v172, v172, v14
    v_perm_b32 v107, v172, v172, v15
    s_cbranch_vccnz L_s222
L_b222:
    s_waitcnt vmcnt(5)
    buffer_load_dwordx4 a[120:123], v4, s[32:35], s72 offen offset:2048 nt
    s_cmp_lg_u32 s3, 3
    s_cbranch_scc1 L_np11
    s_and_b32 s7, s2, 7
    s_mul_i32 s8, s7, 6
    s_lshr_b32 s22, s2, 3
    s_add_u32 s22, s22, s8
    s_add_u32 s22, s22, 25
    s_and_b32 s0, s22, 31
    s_and_b32 s22, s22, 31
    s_lshl_b32 s22, s22, 7
    s_add_u32 s22, s22, 438272
    s_load_dwordx8 s[64:71], s[26:27], s22 glc
    s_lshl_b32 s7, s7, 2
    s_xor_b32 s22, s22, 2048
    s_add_u32 s22, s22, s7
    s_atomic_swap s6, s[26:27], s22
L_np11:
    v_mfma_f32_16x16x32_bf16 v[108:111], v[100:103], a[96:99], v[108:111]
    v_mfma_f32_16x16x32_bf16 v[112:115], v[104:107], a[96:99], v[112:115]
L_mlchk:
    v_bitop3_b32 v125, v188, v189, v7 bitop3:0x7e
    v_bitop3_b32 v126, v190, v191, v7 bitop3:0x7e
    v_lshlrev_b32 v125, 16, v125
    v_and_or_b32 v125, v126, s15, v125
    v_cmp_ne_u32 vcc, 0, v125
    s_cbranch_vccnz L_mlretry
L_mlok:
    s_cmp_lg_u32 s21, 0
    s_cselect_b64 vcc, -1, 0
    v_and_b32 v188, s5, v188
    v_and_b32 v189, s5, v189
    v_xor_b32 v190, v190, v250
    v_xor_b32 v191, v191, v250
    v_mov_b32 v192, v188
    v_mov_b32 v193, v189
    s_nop 0
    v_max_f32_dpp v192, v192, v192 row_ror:8 row_mask:0xf bank_mask:0xf
    v_max_f32_dpp v193, v193, v193 row_ror:8 row_mask:0xf bank_mask:0xf
    s_nop 0
    v_max_f32_dpp v192, v192, v192 row_ror:4 row_mask:0xf bank_mask:0xf
    v_max_f32_dpp v193, v193, v193 row_ror:4 row_mask:0xf bank_mask:0xf
    s_nop 0
    v_max_f32_dpp v192, v192, v192 row_ror:2 row_mask:0xf bank_mask:0xf
    v_max_f32_dpp v193, v193, v193 row_ror:2 row_mask:0xf bank_mask:0xf
    s_nop 0
    v_max_f32_dpp v192, v192, v192 row_ror:1 row_mask:0xf bank_mask:0xf
    v_max_f32_dpp v193, v193, v193 row_ror:1 row_mask:0xf bank_mask:0xf
    v_sub_f32 v188, v188, v192
    v_sub_f32 v189, v189, v193
    v_sub_f32 v122, v116, v192
    v_sub_f32 v123, v117, v193
    v_mul_f32 v188, s75, v188
    v_mul_f32 v189, s75, v189
    v_mul_f32 v122, s75, v122
    v_mul_f32 v123, s75, v123
    s_cbranch_vccnz L_s223
L_b223:
    s_waitcnt vmcnt(5)
    buffer_load_dwordx4 a[124:127], v4, s[32:35], s72 offen offset:3072 nt
    v_perm_b32 v100, v173, v173, v8
    v_perm_b32 v101, v173, v173, v9
    v_perm_b32 v102, v173, v173, v10
    v_perm_b32 v103, v173, v173, v11
    v_perm_b32 v104, v173, v173, v12
    v_perm_b32 v105, v173, v173, v13
    v_perm_b32 v106, v173, v173, v14
    v_perm_b32 v107, v173, v173, v15
    v_mfma_f32_16x16x32_bf16 v[108:111], v[100:103], a[100:103], v[108:111]
    s_nop 0
    v_mfma_f32_16x16x32_bf16 v[112:115], v[104:107], a[100:103], v[112:115]
    v_perm_b32 v100, v174, v174, v8
    v_perm_b32 v101, v174, v174, v9
    v_perm_b32 v102, v174, v174, v10
    v_perm_b32 v103, v174, v174, v11
    v_perm_b32 v104, v174, v174, v12
    v_perm_b32 v105, v174, v174, v13
    v_perm_b32 v106, v174, v174, v14
    v_perm_b32 v107, v174, v174, v15
    s_add_u32 s72, s101, 1835008
    s_cbranch_vccnz L_s224
L_b224:
    s_waitcnt vmcnt(5)
    buffer_load_dwordx4 a[0:3], v4, s[32:35], s72 offen offset:0 nt
    v_mfma_f32_16x16x32_bf16 v[108:111], v[100:103], a[104:107], v[108:111]
    v_mfma_f32_16x16x32_bf16 v[112:115], v[104:107], a[104:107], v[112:115]
    v_exp_f32 v188, v188
    v_exp_f32 v189, v189
    v_exp_f32 v122, v122
    v_exp_f32 v123, v123
    v_mul_f32 v188, v188, v190
    v_mul_f32 v189, v189, v191
    s_nop 0
    v_add_f32_dpp v188, v188, v188 row_ror:8 row_mask:0xf bank_mask:0xf
    v_add_f32_dpp v189, v189, v189 row_ror:8 row_mask:0xf bank_mask:0xf
    s_nop 0
    v_add_f32_dpp v188, v188, v188 row_ror:4 row_mask:0xf bank_mask:0xf
    v_add_f32_dpp v189, v189, v189 row_ror:4 row_mask:0xf bank_mask:0xf
    s_nop 0
    v_add_f32_dpp v188, v188, v188 row_ror:2 row_mask:0xf bank_mask:0xf
    v_add_f32_dpp v189, v189, v189 row_ror:2 row_mask:0xf bank_mask:0xf
    s_nop 0
    v_add_f32_dpp v188, v188, v188 row_ror:1 row_mask:0xf bank_mask:0xf
    v_add_f32_dpp v189, v189, v189 row_ror:1 row_mask:0xf bank_mask:0xf
    v_rcp_f32 v188, v188
    v_rcp_f32 v189, v189
    v_mul_f32 v122, v122, v188
    v_mul_f32 v123, v123, v189
    v_perm_b32 v100, v175, v175, v8
    v_perm_b32 v101, v175, v175, v9
    v_perm_b32 v102, v175, v175, v10
    v_perm_b32 v103, v175, v175, v11
    v_perm_b32 v104, v175, v175, v12
    v_perm_b32 v105, v175, v175, v13
    v_perm_b32 v106, v175, v175, v14
    v_perm_b32 v107, v175, v175, v15
    s_cbranch_vccnz L_s225
L_b225:
    s_waitcnt vmcnt(5)
    buffer_load_dwordx4 a[4:7], v4, s[32:35], s72 offen offset:1024 nt
    v_mfma_f32_16x16x32_bf16 v[108:111], v[100:103], a[108:111], v[108:111]
    v_mfma_f32_16x16x32_bf16 v[112:115], v[104:107], a[108:111], v[112:115]
    v_perm_b32 v100, v176, v176, v8
    v_perm_b32 v101, v176, v176, v9
    v_perm_b32 v102, v176, v176, v10
    v_perm_b32 v103, v176, v176, v11
    v_perm_b32 v104, v176, v176, v12
    v_perm_b32 v105, v176, v176, v13
    v_perm_b32 v106, v176, v176, v14
    v_perm_b32 v107, v176, v176, v15
    s_cbranch_vccnz L_s226
L_b226:
    s_waitcnt vmcnt(5)
    buffer_load_dwordx4 a[8:11], v4, s[32:35], s72 offen offset:2048 nt
    v_mfma_f32_16x16x32_bf16 v[108:111], v[100:103], a[112:115], v[108:111]
    v_mfma_f32_16x16x32_bf16 v[112:115], v[104:107], a[112:115], v[112:115]
    v_perm_b32 v100, v177, v177, v8
    v_perm_b32 v101, v177, v177, v9
    v_perm_b32 v102, v177, v177, v10
    v_perm_b32 v103, v177, v177, v11
    v_perm_b32 v104, v177, v177, v12
    v_perm_b32 v105, v177, v177, v13
    v_perm_b32 v106, v177, v177, v14
    v_perm_b32 v107, v177, v177, v15
    s_cbranch_vccnz L_s227
L_b227:
    s_waitcnt vmcnt(5)
    buffer_load_dwordx4 a[12:15], v4, s[32:35], s72 offen offset:3072 nt
    v_mfma_f32_16x16x32_bf16 v[108:111], v[100:103], a[116:119], v[108:111]
    v_mfma_f32_16x16x32_bf16 v[112:115], v[104:107], a[116:119], v[112:115]
    v_perm_b32 v100, v178, v178, v8
    v_perm_b32 v101, v178, v178, v9
    v_perm_b32 v102, v178, v178, v10
    v_perm_b32 v103, v178, v178, v11
    v_perm_b32 v104, v178, v178, v12
    v_perm_b32 v105, v178, v178, v13
    v_perm_b32 v106, v178, v178, v14
    v_perm_b32 v107, v178, v178, v15
    s_add_u32 s72, s101, 1851392
    s_cbranch_vccnz L_s228
L_b228:
    s_waitcnt vmcnt(5)
    buffer_load_dwordx4 a[16:19], v4, s[32:35], s72 offen offset:0 nt
    v_mfma_f32_16x16x32_bf16 v[108:111], v[100:103], a[120:123], v[108:111]
    v_mfma_f32_16x16x32_bf16 v[112:115], v[104:107], a[120:123], v[112:115]
    v_perm_b32 v100, v179, v179, v8
    v_perm_b32 v101, v179, v179, v9
    v_perm_b32 v102, v179, v179, v10
    v_perm_b32 v103, v179, v179, v11
    v_perm_b32 v104, v179, v179, v12
    v_perm_b32 v105, v179, v179, v13
    v_perm_b32 v106, v179, v179, v14
    v_perm_b32 v107, v179, v179, v15
    s_cbranch_vccnz L_s229
L_b229:
    s_waitcnt vmcnt(5)
    buffer_load_dwordx4 a[20:23], v4, s[32:35], s72 offen offset:1024 nt
    s_lshr_b32 s7, s2, 3
    s_and_b32 s7, s7, 15
    s_cmp_lg_u32 s7, 3
    s_cbranch_scc1 L_nr7
    s_getpc_b64 s[0:1]
L_rp7:
    s_add_u32 s0, s0, 1536
    s_addc_u32 s1, s1, 0
    global_load_dwordx4 v[228:231], v255, s[0:1]
L_nr7:
    v_mfma_f32_16x16x32_bf16 v[108:111], v[100:103], a[124:127], v[108:111]
    v_mfma_f32_16x16x32_bf16 v[112:115], v[104:107], a[124:127], v[112:115]
    v_perm_b32 v100, v180, v180, v8
    v_perm_b32 v101, v180, v180, v9
    v_perm_b32 v102, v180, v180, v10
    v_perm_b32 v103, v180, v180, v11
    v_perm_b32 v104, v180, v180, v12
    v_perm_b32 v105, v180, v180, v13
    v_perm_b32 v106, v180, v180, v14
    v_perm_b32 v107, v180, v180, v15
    s_cbranch_vccnz L_s230
L_b230:
    s_waitcnt vmcnt(5)
    buffer_load_dwordx4 a[24:27], v4, s[32:35], s72 offen offset:2048 nt
    s_cmp_lg_u32 s3, 3
    s_cbranch_scc1 L_ng11
    s_waitcnt lgkmcnt(0)
    s_cmp_eq_u32 s100, 0
    s_cselect_b32 s7, -3, 0
    s_cmp_eq_u32 s64, s6
    s_addc_u32 s7, s7, 0
    s_cmp_eq_u32 s65, s6
    s_addc_u32 s7, s7, 0
    s_cmp_eq_u32 s66, s6
    s_addc_u32 s7, s7, 0
    s_cmp_eq_u32 s67, s6
    s_addc_u32 s7, s7, 0
    s_cmp_eq_u32 s68, s6
    s_addc_u32 s7, s7, 0
    s_cmp_eq_u32 s69, s6
    s_addc_u32 s7, s7, 0
    s_cmp_eq_u32 s70, s6
    s_addc_u32 s7, s7, 0
    s_cmp_eq_u32 s71, s6
    s_addc_u32 s7, s7, 0
    s_cmp_lt_i32 s7, 4
    s_cselect_b32 s21, 1, 0
    v_mov_b32 v137, s21
    ds_write_b32 v243, v137
L_ng11:
    v_mfma_f32_16x16x32_bf16 v[108:111], v[100:103], a[0:3], v[108:111]
    v_mfma_f32_16x16x32_bf16 v[112:115], v[104:107], a[0:3], v[112:115]
    v_perm_b32 v100, v181, v181, v8
    v_perm_b32 v101, v181, v181, v9
    v_perm_b32 v102, v181, v181, v10
    v_perm_b32 v103, v181, v181, v11
    v_perm_b32 v104, v181, v181, v12
    v_perm_b32 v105, v181, v181, v13
    v_perm_b32 v106, v181, v181, v14
    v_perm_b32 v107, v181, v181, v15
    s_cbranch_vccnz L_s231
L_b231:
    s_waitcnt vmcnt(5)
    buffer_load_dwordx4 a[28:31], v4, s[32:35], s72 offen offset:3072 nt
    v_mfma_f32_16x16x32_bf16 v[108:111], v[100:103], a[4:7], v[108:111]
    v_mfma_f32_16x16x32_bf16 v[112:115], v[104:107], a[4:7], v[112:115]
    v_perm_b32 v100, v182, v182, v8
    v_perm_b32 v101, v182, v182, v9
    v_perm_b32 v102, v182, v182, v10
    v_perm_b32 v103, v182, v182, v11
    v_perm_b32 v104, v182, v182, v12
    v_perm_b32 v105, v182, v182, v13
    v_perm_b32 v106, v182, v182, v14
    v_perm_b32 v107, v182, v182, v15
    s_add_u32 s72, s101, 1966080
    s_cbranch_vccnz L_s232
L_b232:
    s_waitcnt vmcnt(5)
    buffer_load_dwordx4 a[32:35], v4, s[32:35], s72 offen offset:0 nt
    ds_read_b32 v137, v243
    v_mfma_f32_16x16x32_bf16 v[108:111], v[100:103], a[8:11], v[108:111]
    v_mfma_f32_16x16x32_bf16 v[112:115], v[104:107], a[8:11], v[112:115]
    v_perm_b32 v100, v183, v183, v8
    v_perm_b32 v101, v183, v183, v9
    v_perm_b32 v102, v183, v183, v10
    v_perm_b32 v103, v183, v183, v11
    v_perm_b32 v104, v183, v183, v12
    v_perm_b32 v105, v183, v183, v13
    v_perm_b32 v106, v183, v183, v14
    v_perm_b32 v107, v183, v183, v15
    s_cbranch_vccnz L_s233
L_b233:
    s_waitcnt vmcnt(5)
    buffer_load_dwordx4 a[36:39], v4, s[32:35], s72 offen offset:1024 nt
    s_waitcnt lgkmcnt(0)
    v_readfirstlane_b32 s21, v137
    s_and_b32 s21, s21, 3
    s_cmp_lg_u32 s21, 0
    s_cselect_b64 vcc, -1, 0
    v_mfma_f32_16x16x32_bf16 v[108:111], v[100:103], a[12:15], v[108:111]
    v_mfma_f32_16x16x32_bf16 v[112:115], v[104:107], a[12:15], v[112:115]
    v_perm_b32 v100, v184, v184, v8
    v_perm_b32 v101, v184, v184, v9
    v_perm_b32 v102, v184, v184, v10
    v_perm_b32 v103, v184, v184, v11
    v_perm_b32 v104, v184, v184, v12
    v_perm_b32 v105, v184, v184, v13
    v_perm_b32 v106, v184, v184, v14
    v_perm_b32 v107, v184, v184, v15
    s_cbranch_vccnz L_s234
L_b234:
    s_waitcnt vmcnt(5)
    buffer_load_dwordx4 a[40:43], v4, s[32:35], s72 offen offset:2048 nt
    v_mfma_f32_16x16x32_bf16 v[108:111], v[100:103], a[16:19], v[108:111]
    v_mfma_f32_16x16x32_bf16 v[112:115], v[104:107], a[16:19], v[112:115]
    ds_read_b128 v[156:159], v6 offset:4096
    ds_read_b128 v[160:163], v6 offset:4112
    ds_read_b128 v[164:167], v6 offset:0
    ds_read_b128 v[168:171], v6 offset:16
    v_perm_b32 v100, v185, v185, v8
    v_perm_b32 v101, v185, v185, v9
    v_perm_b32 v102, v185, v185, v10
    v_perm_b32 v103, v185, v185, v11
    v_perm_b32 v104, v185, v185, v12
    v_perm_b32 v105, v185, v185, v13
    v_perm_b32 v106, v185, v185, v14
    v_perm_b32 v107, v185, v185, v15
    s_cbranch_vccnz L_s235
L_b235:
    s_waitcnt vmcnt(5)
    buffer_load_dwordx4 a[44:47], v4, s[32:35], s72 offen offset:3072 nt
    v_mfma_f32_16x16x32_bf16 v[108:111], v[100:103], a[20:23], v[108:111]
    v_mfma_f32_16x16x32_bf16 v[112:115], v[104:107], a[20:23], v[112:115]
    v_perm_b32 v100, v186, v186, v8
    v_perm_b32 v101, v186, v186, v9
    v_perm_b32 v102, v186, v186, v10
    v_perm_b32 v103, v186, v186, v11
    v_perm_b32 v104, v186, v186, v12
    v_perm_b32 v105, v186, v186, v13
    v_perm_b32 v106, v186, v186, v14
    v_perm_b32 v107, v186, v186, v15
    s_add_u32 s72, s101, 1982464
    s_cbranch_vccnz L_s236
L_b236:
    s_waitcnt vmcnt(5)
    buffer_load_dwordx4 a[48:51], v4, s[32:35], s72 offen offset:0 nt
    v_mfma_f32_16x16x32_bf16 v[108:111], v[100:103], a[24:27], v[108:111]
    v_mfma_f32_16x16x32_bf16 v[112:115], v[104:107], a[24:27], v[112:115]
    v_perm_b32 v100, v187, v187, v8
    v_perm_b32 v101, v187, v187, v9
    v_perm_b32 v102, v187, v187, v10
    v_perm_b32 v103, v187, v187, v11
    v_perm_b32 v104, v187, v187, v12
    v_perm_b32 v105, v187, v187, v13
    v_perm_b32 v106, v187, v187, v14
    v_perm_b32 v107, v187, v187, v15
    s_cbranch_vccnz L_s237
L_b237:
    s_waitcnt vmcnt(5)
    buffer_load_dwordx4 a[52:55], v4, s[32:35], s72 offen offset:1024 nt
    v_mfma_f32_16x16x32_bf16 v[108:111], v[100:103], a[28:31], v[108:111]
    v_mfma_f32_16x16x32_bf16 v[112:115], v[104:107], a[28:31], v[112:115]
    s_waitcnt lgkmcnt(0)
    v_perm_b32 v100, v156, v156, v8
    v_perm_b32 v101, v156, v156, v9
    v_perm_b32 v102, v156, v156, v10
    v_perm_b32 v103, v156, v156, v11
    v_perm_b32 v104, v156, v156, v12
    v_perm_b32 v105, v156, v156, v13
    v_perm_b32 v106, v156, v156, v14
    v_perm_b32 v107, v156, v156, v15
    s_cbranch_vccnz L_s238
L_b238:
    s_waitcnt vmcnt(5)
    buffer_load_dwordx4 a[56:59], v4, s[32:35], s72 offen offset:2048 nt
    s_cmp_lg_u32 s3, 0
    s_cbranch_scc1 L_np12
    s_and_b32 s7, s2, 7
    s_mul_i32 s8, s7, 9
    s_lshr_b32 s22, s2, 3
    s_add_u32 s22, s22, s8
    s_add_u32 s22, s22, 4
    s_and_b32 s0, s22, 31
    s_and_b32 s22, s22, 31
    s_lshl_b32 s22, s22, 7
    s_add_u32 s22, s22, 442368
    s_load_dwordx8 s[64:71], s[26:27], s22 glc
    s_lshl_b32 s7, s7, 2
    s_xor_b32 s22, s22, 2048
    s_add_u32 s22, s22, s7
    s_atomic_swap s6, s[26:27], s22
L_np12:
    v_mfma_f32_16x16x32_bf16 v[108:111], v[100:103], a[32:35], v[108:111]
    v_mfma_f32_16x16x32_bf16 v[112:115], v[104:107], a[32:35], v[112:115]
    v_perm_b32 v100, v157, v157, v8
    v_perm_b32 v101, v157, v157, v9
    v_perm_b32 v102, v157, v157, v10
    v_perm_b32 v103, v157, v157, v11
    v_perm_b32 v104, v157, v157, v12
    v_perm_b32 v105, v157, v157, v13
    v_perm_b32 v106, v157, v157, v14
    v_perm_b32 v107, v157, v157, v15
    s_cbranch_vccnz L_s239
L_b239:
    s_waitcnt vmcnt(5)
    buffer_load_dwordx4 a[60:63], v4, s[32:35], s72 offen offset:3072 nt
    v_mfma_f32_16x16x32_bf16 v[108:111], v[100:103], a[36:39], v[108:111]
    v_mfma_f32_16x16x32_bf16 v[112:115], v[104:107], a[36:39], v[112:115]
    v_perm_b32 v100, v158, v158, v8
    v_perm_b32 v101, v158, v158, v9
    v_perm_b32 v102, v158, v158, v10
    v_perm_b32 v103, v158, v158, v11
    v_perm_b32 v104, v158, v158, v12
    v_perm_b32 v105, v158, v158, v13
    v_perm_b32 v106, v158, v158, v14
    v_perm_b32 v107, v158, v158, v15
    s_cmp_eq_u32 s100, 0
    s_cbranch_scc1 L_adrain
    s_add_u32 s72, s101, 0
    s_cbranch_vccnz L_s240
L_b240:
    s_waitcnt vmcnt(5)
    buffer_load_dwordx4 a[64:67], v4, s[32:35], s72 offen offset:0 nt
    v_mfma_f32_16x16x32_bf16 v[108:111], v[100:103], a[40:43], v[108:111]
    v_mfma_f32_16x16x32_bf16 v[112:115], v[104:107], a[40:43], v[112:115]
    v_perm_b32 v100, v159, v159, v8
    v_perm_b32 v101, v159, v159, v9
    v_perm_b32 v102, v159, v159, v10
    v_perm_b32 v103, v159, v159, v11
    v_perm_b32 v104, v159, v159, v12
    v_perm_b32 v105, v159, v159, v13
    v_perm_b32 v106, v159, v159, v14
    v_perm_b32 v107, v159, v159, v15
    s_cbranch_vccnz L_s241
L_b241:
    s_waitcnt vmcnt(5)
    buffer_load_dwordx4 a[68:71], v4, s[32:35], s72 offen offset:1024 nt
    v_mfma_f32_16x16x32_bf16 v[108:111], v[100:103], a[44:47], v[108:111]
    v_mfma_f32_16x16x32_bf16 v[112:115], v[104:107], a[44:47], v[112:115]
    v_perm_b32 v100, v160, v160, v8
    v_perm_b32 v101, v160, v160, v9
    v_perm_b32 v102, v160, v160, v10
    v_perm_b32 v103, v160, v160, v11
    v_perm_b32 v104, v160, v160, v12
    v_perm_b32 v105, v160, v160, v13
    v_perm_b32 v106, v160, v160, v14
    v_perm_b32 v107, v160, v160, v15
    s_cbranch_vccnz L_s242
L_b242:
    s_waitcnt vmcnt(5)
    buffer_load_dwordx4 a[72:75], v4, s[32:35], s72 offen offset:2048 nt
    v_mfma_f32_16x16x32_bf16 v[108:111], v[100:103], a[48:51], v[108:111]
    v_mfma_f32_16x16x32_bf16 v[112:115], v[104:107], a[48:51], v[112:115]
    v_perm_b32 v100, v161, v161, v8
    v_perm_b32 v101, v161, v161, v9
    v_perm_b32 v102, v161, v161, v10
    v_perm_b32 v103, v161, v161, v11
    v_perm_b32 v104, v161, v161, v12
    v_perm_b32 v105, v161, v161, v13
    v_perm_b32 v106, v161, v161, v14
    v_perm_b32 v107, v161, v161, v15
    s_cbranch_vccnz L_s243
L_b243:
    s_waitcnt vmcnt(5)
    buffer_load_dwordx4 a[76:79], v4, s[32:35], s72 offen offset:3072 nt
    v_mfma_f32_16x16x32_bf16 v[108:111], v[100:103], a[52:55], v[108:111]
    v_mfma_f32_16x16x32_bf16 v[112:115], v[104:107], a[52:55], v[112:115]
    v_perm_b32 v100, v162, v162, v8
    v_perm_b32 v101, v162, v162, v9
    v_perm_b32 v102, v162, v162, v10
    v_perm_b32 v103, v162, v162, v11
    v_perm_b32 v104, v162, v162, v12
    v_perm_b32 v105, v162, v162, v13
    v_perm_b32 v106, v162, v162, v14
    v_perm_b32 v107, v162, v162, v15
    s_add_u32 s72, s101, 16384
    s_cbranch_vccnz L_s244
L_b244:
    s_waitcnt vmcnt(5)
    buffer_load_dwordx4 a[80:83], v4, s[32:35], s72 offen offset:0 nt
    v_mfma_f32_16x16x32_bf16 v[108:111], v[100:103], a[56:59], v[108:111]
    v_mfma_f32_16x16x32_bf16 v[112:115], v[104:107], a[56:59], v[112:115]
    v_perm_b32 v100, v163, v163, v8
    v_perm_b32 v101, v163, v163, v9
    v_perm_b32 v102, v163, v163, v10
    v_perm_b32 v103, v163, v163, v11
    v_perm_b32 v104, v163, v163, v12
    v_perm_b32 v105, v163, v163, v13
    v_perm_b32 v106, v163, v163, v14
    v_perm_b32 v107, v163, v163, v15
    s_cbranch_vccnz L_s245
L_b245:
    s_waitcnt vmcnt(5)
    buffer_load_dwordx4 a[84:87], v4, s[32:35], s72 offen offset:1024 nt
    v_mfma_f32_16x16x32_bf16 v[108:111], v[100:103], a[60:63], v[108:111]
    v_mfma_f32_16x16x32_bf16 v[112:115], v[104:107], a[60:63], v[112:115]
    v_perm_b32 v100, v164, v164, v8
    v_perm_b32 v101, v164, v164, v9
    v_perm_b32 v102, v164, v164, v10
    v_perm_b32 v103, v164, v164, v11
    v_perm_b32 v104, v164, v164, v12
    v_perm_b32 v105, v164, v164, v13
    v_perm_b32 v106, v164, v164, v14
    v_perm_b32 v107, v164, v164, v15
    s_cbranch_vccnz L_s246
L_b246:
    s_waitcnt vmcnt(5)
    buffer_load_dwordx4 a[88:91], v4, s[32:35], s72 offen offset:2048 nt
    s_cmp_lg_u32 s3, 0
    s_cbranch_scc1 L_ng12
    s_waitcnt lgkmcnt(0)
    s_cmp_eq_u32 s100, 0
    s_cselect_b32 s7, -3, 0
    s_cmp_eq_u32 s64, s6
    s_addc_u32 s7, s7, 0
    s_cmp_eq_u32 s65, s6
    s_addc_u32 s7, s7, 0
    s_cmp_eq_u32 s66, s6
    s_addc_u32 s7, s7, 0
    s_cmp_eq_u32 s67, s6
    s_addc_u32 s7, s7, 0
    s_cmp_eq_u32 s68, s6
    s_addc_u32 s7, s7, 0
    s_cmp_eq_u32 s69, s6
    s_addc_u32 s7, s7, 0
    s_cmp_eq_u32 s70, s6
    s_addc_u32 s7, s7, 0
    s_cmp_eq_u32 s71, s6
    s_addc_u32 s7, s7, 0
    s_cmp_lt_i32 s7, 4
    s_cselect_b32 s21, 1, 0
    v_mov_b32 v137, s21
    ds_write_b32 v243, v137
L_ng12:
    v_mfma_f32_16x16x32_bf16 v[108:111], v[100:103], a[64:67], v[108:111]
    v_mfma_f32_16x16x32_bf16 v[112:115], v[104:107], a[64:67], v[112:115]
    v_perm_b32 v100, v165, v165, v8
    v_perm_b32 v101, v165, v165, v9
    v_perm_b32 v102, v165, v165, v10
    v_perm_b32 v103, v165, v165, v11
    v_perm_b32 v104, v165, v165, v12
    v_perm_b32 v105, v165, v165, v13
    v_perm_b32 v106, v165, v165, v14
    v_perm_b32 v107, v165, v165, v15
    s_cbranch_vccnz L_s247
L_b247:
    s_waitcnt vmcnt(5)
    buffer_load_dwordx4 a[92:95], v4, s[32:35], s72 offen offset:3072 nt
    v_mfma_f32_16x16x32_bf16 v[108:111], v[100:103], a[68:71], v[108:111]
    v_mfma_f32_16x16x32_bf16 v[112:115], v[104:107], a[68:71], v[112:115]
    v_perm_b32 v100, v166, v166, v8
    v_perm_b32 v101, v166, v166, v9
    v_perm_b32 v102, v166, v166, v10
    v_perm_b32 v103, v166, v166, v11
    v_perm_b32 v104, v166, v166, v12
    v_perm_b32 v105, v166, v166, v13
    v_perm_b32 v106, v166, v166, v14
    v_perm_b32 v107, v166, v166, v15
    s_add_u32 s72, s101, 98304
    s_cbranch_vccnz L_s248
L_b248:
    s_waitcnt vmcnt(5)
    buffer_load_dwordx4 a[96:99], v4, s[32:35], s72 offen offset:0 nt
    ds_read_b32 v137, v243
    v_mfma_f32_16x16x32_bf16 v[108:111], v[100:103], a[72:75], v[108:111]
    v_mfma_f32_16x16x32_bf16 v[112:115], v[104:107], a[72:75], v[112:115]
    v_perm_b32 v100, v167, v167, v8
    v_perm_b32 v101, v167, v167, v9
    v_perm_b32 v102, v167, v167, v10
    v_perm_b32 v103, v167, v167, v11
    v_perm_b32 v104, v167, v167, v12
    v_perm_b32 v105, v167, v167, v13
    v_perm_b32 v106, v167, v167, v14
    v_perm_b32 v107, v167, v167, v15
    s_cbranch_vccnz L_s249
L_b249:
    s_waitcnt vmcnt(5)
    buffer_load_dwordx4 a[100:103], v4, s[32:35], s72 offen offset:1024 nt
    s_waitcnt lgkmcnt(0)
    v_readfirstlane_b32 s21, v137
    s_and_b32 s21, s21, 3
    s_cmp_lg_u32 s21, 0
    s_cselect_b64 vcc, -1, 0
    v_mfma_f32_16x16x32_bf16 v[108:111], v[100:103], a[76:79], v[108:111]
    v_mfma_f32_16x16x32_bf16 v[112:115], v[104:107], a[76:79], v[112:115]
    v_perm_b32 v100, v168, v168, v8
    v_perm_b32 v101, v168, v168, v9
    v_perm_b32 v102, v168, v168, v10
    v_perm_b32 v103, v168, v168, v11
    v_perm_b32 v104, v168, v168, v12
    v_perm_b32 v105, v168, v168, v13
    v_perm_b32 v106, v168, v168, v14
    v_perm_b32 v107, v168, v168, v15
    s_cbranch_vccnz L_s250
L_b250:
    s_waitcnt vmcnt(5)
    buffer_load_dwordx4 a[104:107], v4, s[32:35], s72 offen offset:2048 nt
    v_mfma_f32_16x16x32_bf16 v[108:111], v[100:103], a[80:83], v[108:111]
    v_mfma_f32_16x16x32_bf16 v[112:115], v[104:107], a[80:83], v[112:115]
    ds_read_b128 v[172:175], v6 offset:256
    ds_read_b128 v[176:179], v6 offset:272
    ds_read_b128 v[180:183], v6 offset:512
    ds_read_b128 v[184:187], v6 offset:528
    v_perm_b32 v100, v169, v169, v8
    v_perm_b32 v101, v169, v169, v9
    v_perm_b32 v102, v169, v169, v10
    v_perm_b32 v103, v169, v169, v11
    v_perm_b32 v104, v169, v169, v12
    v_perm_b32 v105, v169, v169, v13
    v_perm_b32 v106, v169, v169, v14
    v_perm_b32 v107, v169, v169, v15
    s_cbranch_vccnz L_s251
L_b251:
    s_waitcnt vmcnt(5)
    buffer_load_dwordx4 a[108:111], v4, s[32:35], s72 offen offset:3072 nt
    v_mfma_f32_16x16x32_bf16 v[108:111], v[100:103], a[84:87], v[108:111]
    v_mfma_f32_16x16x32_bf16 v[112:115], v[104:107], a[84:87], v[112:115]
    v_perm_b32 v100, v170, v170, v8
    v_perm_b32 v101, v170, v170, v9
    v_perm_b32 v102, v170, v170, v10
    v_perm_b32 v103, v170, v170, v11
    v_perm_b32 v104, v170, v170, v12
    v_perm_b32 v105, v170, v170, v13
    v_perm_b32 v106, v170, v170, v14
    v_perm_b32 v107, v170, v170, v15
    s_add_u32 s72, s101, 114688
    s_cbranch_vccnz L_s252
L_b252:
    s_waitcnt vmcnt(5)
    buffer_load_dwordx4 a[112:115], v4, s[32:35], s72 offen offset:0 nt
    v_mfma_f32_16x16x32_bf16 v[108:111], v[100:103], a[88:91], v[108:111]
    v_mfma_f32_16x16x32_bf16 v[112:115], v[104:107], a[88:91], v[112:115]
    v_perm_b32 v100, v171, v171, v8
    v_perm_b32 v101, v171, v171, v9
    v_perm_b32 v102, v171, v171, v10
    v_perm_b32 v103, v171, v171, v11
    v_perm_b32 v104, v171, v171, v12
    v_perm_b32 v105, v171, v171, v13
    v_perm_b32 v106, v171, v171, v14
    v_perm_b32 v107, v171, v171, v15
    s_cbranch_vccnz L_s253
L_b253:
    s_waitcnt vmcnt(5)
    buffer_load_dwordx4 a[116:119], v4, s[32:35], s72 offen offset:1024 nt
    v_mfma_f32_16x16x32_bf16 v[108:111], v[100:103], a[92:95], v[108:111]
    v_mfma_f32_16x16x32_bf16 v[112:115], v[104:107], a[92:95], v[112:115]
    s_waitcnt lgkmcnt(0)
    v_perm_b32 v100, v172, v172, v8
    v_perm_b32 v101, v172, v172, v9
    v_perm_b32 v102, v172, v172, v10
    v_perm_b32 v103, v172, v172, v11
    v_perm_b32 v104, v172, v172, v12
    v_perm_b32 v105, v172, v172, v13
    v_perm_b32 v106, v172, v172, v14
    v_perm_b32 v107, v172, v172, v15
    s_cbranch_vccnz L_s254
L_b254:
    s_waitcnt vmcnt(5)
    buffer_load_dwordx4 a[120:123], v4, s[32:35], s72 offen offset:2048 nt
    v_mfma_f32_16x16x32_bf16 v[108:111], v[100:103], a[96:99], v[108:111]
    v_mfma_f32_16x16x32_bf16 v[112:115], v[104:107], a[96:99], v[112:115]
    v_perm_b32 v100, v173, v173, v8
    v_perm_b32 v101, v173, v173, v9
    v_perm_b32 v102, v173, v173, v10
    v_perm_b32 v103, v173, v173, v11
    v_perm_b32 v104, v173, v173, v12
    v_perm_b32 v105, v173, v173, v13
    v_perm_b32 v106, v173, v173, v14
    v_perm_b32 v107, v173, v173, v15
    s_cbranch_vccnz L_s255
L_b255:
    s_waitcnt vmcnt(5)
    buffer_load_dwordx4 a[124:127], v4, s[32:35], s72 offen offset:3072 nt
    v_mfma_f32_16x16x32_bf16 v[108:111], v[100:103], a[100:103], v[108:111]
    v_mfma_f32_16x16x32_bf16 v[112:115], v[104:107], a[100:103], v[112:115]
    v_perm_b32 v100, v174, v174, v8
    v_perm_b32 v101, v174, v174, v9
    v_perm_b32 v102, v174, v174, v10
    v_perm_b32 v103, v174, v174, v11
    v_perm_b32 v104, v174, v174, v12
    v_perm_b32 v105, v174, v174, v13
    v_perm_b32 v106, v174, v174, v14
    v_perm_b32 v107, v174, v174, v15
    s_add_u32 s72, s101, 196608
    s_cbranch_vccnz L_s256
L_b256:
    buffer_load_dwordx4 a[0:3], v4, s[32:35], s72 offen offset:0 nt
    s_cbranch_vccnz L_s257
L_b257:
    buffer_load_dwordx4 a[4:7], v4, s[32:35], s72 offen offset:1024 nt
    s_cbranch_vccnz L_s258
L_b258:
    buffer_load_dwordx4 a[8:11], v4, s[32:35], s72 offen offset:2048 nt
    s_cbranch_vccnz L_s259
L_b259:
    s_waitcnt vmcnt(8)
    buffer_load_dwordx4 a[12:15], v4, s[32:35], s72 offen offset:3072 nt
    v_mfma_f32_16x16x32_bf16 v[108:111], v[100:103], a[104:107], v[108:111]
    v_mfma_f32_16x16x32_bf16 v[112:115], v[104:107], a[104:107], v[112:115]
    v_perm_b32 v100, v175, v175, v8
    v_perm_b32 v101, v175, v175, v9
    v_perm_b32 v102, v175, v175, v10
    v_perm_b32 v103, v175, v175, v11
    v_perm_b32 v104, v175, v175, v12
    v_perm_b32 v105, v175, v175, v13
    v_perm_b32 v106, v175, v175, v14
    v_perm_b32 v107, v175, v175, v15
    s_add_u32 s72, s101, 212992
    s_cbranch_vccnz L_s260
L_b260:
    s_waitcnt vmcnt(8)
    buffer_load_dwordx4 a[16:19], v4, s[32:35], s72 offen offset:0 nt
    v_mfma_f32_16x16x32_bf16 v[108:111], v[100:103], a[108:111], v[108:111]
    v_mfma_f32_16x16x32_bf16 v[112:115], v[104:107], a[108:111], v[112:115]
    v_perm_b32 v100, v176, v176, v8
    v_perm_b32 v101, v176, v176, v9
    v_perm_b32 v102, v176, v176, v10
    v_perm_b32 v103, v176, v176, v11
    v_perm_b32 v104, v176, v176, v12
    v_perm_b32 v105, v176, v176, v13
    v_perm_b32 v106, v176, v176, v14
    v_perm_b32 v107, v176, v176, v15
    s_cbranch_vccnz L_s261
L_b261:
    s_waitcnt vmcnt(8)
    buffer_load_dwordx4 a[20:23], v4, s[32:35], s72 offen offset:1024 nt
    v_mfma_f32_16x16x32_bf16 v[108:111], v[100:103], a[112:115], v[108:111]
    v_mfma_f32_16x16x32_bf16 v[112:115], v[104:107], a[112:115], v[112:115]
    ds_read_b128 v[156:159], v6 offset:768
    ds_read_b128 v[160:163], v6 offset:784
    v_perm_b32 v100, v177, v177, v8
    v_perm_b32 v101, v177, v177, v9
    v_perm_b32 v102, v177, v177, v10
    v_perm_b32 v103, v177, v177, v11
    v_perm_b32 v104, v177, v177, v12
    v_perm_b32 v105, v177, v177, v13
    v_perm_b32 v106, v177, v177, v14
    v_perm_b32 v107, v177, v177, v15
    s_cbranch_vccnz L_s262
L_b262:
    s_waitcnt vmcnt(8)
    buffer_load_dwordx4 a[24:27], v4, s[32:35], s72 offen offset:2048 nt
    v_mfma_f32_16x16x32_bf16 v[108:111], v[100:103], a[116:119], v[108:111]
    v_mfma_f32_16x16x32_bf16 v[112:115], v[104:107], a[116:119], v[112:115]
    v_perm_b32 v100, v178, v178, v8
    v_perm_b32 v101, v178, v178, v9
    v_perm_b32 v102, v178, v178, v10
    v_perm_b32 v103, v178, v178, v11
    v_perm_b32 v104, v178, v178, v12
    v_perm_b32 v105, v178, v178, v13
    v_perm_b32 v106, v178, v178, v14
    v_perm_b32 v107, v178, v178, v15
    s_cbranch_vccnz L_s263
L_b263:
    s_waitcnt vmcnt(8)
    buffer_load_dwordx4 a[28:31], v4, s[32:35], s72 offen offset:3072 nt
    v_mfma_f32_16x16x32_bf16 v[108:111], v[100:103], a[120:123], v[108:111]
    v_mfma_f32_16x16x32_bf16 v[112:115], v[104:107], a[120:123], v[112:115]
    v_perm_b32 v100, v179, v179, v8
    v_perm_b32 v101, v179, v179, v9
    v_perm_b32 v102, v179, v179, v10
    v_perm_b32 v103, v179, v179, v11
    v_perm_b32 v104, v179, v179, v12
    v_perm_b32 v105, v179, v179, v13
    v_perm_b32 v106, v179, v179, v14
    v_perm_b32 v107, v179, v179, v15
    s_add_u32 s72, s101, 294912
    s_cbranch_vccnz L_s264
L_b264:
    s_waitcnt vmcnt(8)
    buffer_load_dwordx4 a[32:35], v4, s[32:35], s72 offen offset:0 nt
    v_mfma_f32_16x16x32_bf16 v[108:111], v[100:103], a[124:127], v[108:111]
    v_mfma_f32_16x16x32_bf16 v[112:115], v[104:107], a[124:127], v[112:115]
    v_perm_b32 v100, v180, v180, v8
    v_perm_b32 v101, v180, v180, v9
    v_perm_b32 v102, v180, v180, v10
    v_perm_b32 v103, v180, v180, v11
    v_perm_b32 v104, v180, v180, v12
    v_perm_b32 v105, v180, v180, v13
    v_perm_b32 v106, v180, v180, v14
    v_perm_b32 v107, v180, v180, v15
    s_cbranch_vccnz L_s265
L_b265:
    s_waitcnt vmcnt(8)
    buffer_load_dwordx4 a[36:39], v4, s[32:35], s72 offen offset:1024 nt
    v_mfma_f32_16x16x32_bf16 v[108:111], v[100:103], a[0:3], v[108:111]
    v_mfma_f32_16x16x32_bf16 v[112:115], v[104:107], a[0:3], v[112:115]
    v_perm_b32 v100, v181, v181, v8
    v_perm_b32 v101, v181, v181, v9
    v_perm_b32 v102, v181, v181, v10
    v_perm_b32 v103, v181, v181, v11
    v_perm_b32 v104, v181, v181, v12
    v_perm_b32 v105, v181, v181, v13
    v_perm_b32 v106, v181, v181, v14
    v_perm_b32 v107, v181, v181, v15
    s_cbranch_vccnz L_s266
L_b266:
    s_waitcnt vmcnt(8)
    buffer_load_dwordx4 a[40:43], v4, s[32:35], s72 offen offset:2048 nt
    v_mfma_f32_16x16x32_bf16 v[108:111], v[100:103], a[4:7], v[108:111]
    v_mfma_f32_16x16x32_bf16 v[112:115], v[104:107], a[4:7], v[112:115]
    v_perm_b32 v100, v182, v182, v8
    v_perm_b32 v101, v182, v182, v9
    v_perm_b32 v102, v182, v182, v10
    v_perm_b32 v103, v182, v182, v11
    v_perm_b32 v104, v182, v182, v12
    v_perm_b32 v105, v182, v182, v13
    v_perm_b32 v106, v182, v182, v14
    v_perm_b32 v107, v182, v182, v15
    s_cbranch_vccnz L_s267
L_b267:
    s_waitcnt vmcnt(8)
    buffer_load_dwordx4 a[44:47], v4, s[32:35], s72 offen offset:3072 nt
    v_mfma_f32_16x16x32_bf16 v[108:111], v[100:103], a[8:11], v[108:111]
    v_mfma_f32_16x16x32_bf16 v[112:115], v[104:107], a[8:11], v[112:115]
    v_perm_b32 v100, v183, v183, v8
    v_perm_b32 v101, v183, v183, v9
    v_perm_b32 v102, v183, v183, v10
    v_perm_b32 v103, v183, v183, v11
    v_perm_b32 v104, v183, v183, v12
    v_perm_b32 v105, v183, v183, v13
    v_perm_b32 v106, v183, v183, v14
    v_perm_b32 v107, v183, v183, v15
    s_add_u32 s72, s101, 311296
    s_cbranch_vccnz L_s268
L_b268:
    s_waitcnt vmcnt(8)
    buffer_load_dwordx4 a[48:51], v4, s[32:35], s72 offen offset:0 nt
    v_mfma_f32_16x16x32_bf16 v[108:111], v[100:103], a[12:15], v[108:111]
    v_mfma_f32_16x16x32_bf16 v[112:115], v[104:107], a[12:15], v[112:115]
    v_perm_b32 v100, v184, v184, v8
    v_perm_b32 v101, v184, v184, v9
    v_perm_b32 v102, v184, v184, v10
    v_perm_b32 v103, v184, v184, v11
    v_perm_b32 v104, v184, v184, v12
    v_perm_b32 v105, v184, v184, v13
    v_perm_b32 v106, v184, v184, v14
    v_perm_b32 v107, v184, v184, v15
    s_waitcnt lgkmcnt(0)
    v_perm_b32 v32, v156, v156, v8
    v_perm_b32 v33, v156, v156, v9
    v_perm_b32 v34, v156, v156, v10
    v_perm_b32 v35, v156, v156, v11
    v_perm_b32 v36, v156, v156, v12
    v_perm_b32 v37, v156, v156, v13
    v_perm_b32 v38, v156, v156, v14
    v_perm_b32 v39, v156, v156, v15
    v_perm_b32 v40, v157, v157, v8
    v_perm_b32 v41, v157, v157, v9
    v_perm_b32 v42, v157, v157, v10
    v_perm_b32 v43, v157, v157, v11
    v_perm_b32 v44, v157, v157, v12
    v_perm_b32 v45, v157, v157, v13
    v_perm_b32 v46, v157, v157, v14
    v_perm_b32 v47, v157, v157, v15
    s_cbranch_vccnz L_s269
L_b269:
    s_waitcnt vmcnt(8)
    buffer_load_dwordx4 a[52:55], v4, s[32:35], s72 offen offset:1024 nt
    v_mfma_f32_16x16x32_bf16 v[108:111], v[100:103], a[16:19], v[108:111]
    v_mfma_f32_16x16x32_bf16 v[112:115], v[104:107], a[16:19], v[112:115]
    v_perm_b32 v100, v185, v185, v8
    v_perm_b32 v101, v185, v185, v9
    v_perm_b32 v102, v185, v185, v10
    v_perm_b32 v103, v185, v185, v11
    v_perm_b32 v104, v185, v185, v12
    v_perm_b32 v105, v185, v185, v13
    v_perm_b32 v106, v185, v185, v14
    v_perm_b32 v107, v185, v185, v15
    v_perm_b32 v48, v158, v158, v8
    v_perm_b32 v49, v158, v158, v9
    v_perm_b32 v50, v158, v158, v10
    v_perm_b32 v51, v158, v158, v11
    v_perm_b32 v52, v158, v158, v12
    v_perm_b32 v53, v158, v158, v13
    v_perm_b32 v54, v158, v158, v14
    v_perm_b32 v55, v158, v158, v15
    v_perm_b32 v56, v159, v159, v8
    v_perm_b32 v57, v159, v159, v9
    v_perm_b32 v58, v159, v159, v10
    v_perm_b32 v59, v159, v159, v11
    v_perm_b32 v60, v159, v159, v12
    v_perm_b32 v61, v159, v159, v13
    v_perm_b32 v62, v159, v159, v14
    v_perm_b32 v63, v159, v159, v15
    s_cbranch_vccnz L_s270
L_b270:
    s_waitcnt vmcnt(8)
    buffer_load_dwordx4 a[56:59], v4, s[32:35], s72 offen offset:2048 nt
    v_mfma_f32_16x16x32_bf16 v[108:111], v[100:103], a[20:23], v[108:111]
    v_mfma_f32_16x16x32_bf16 v[112:115], v[104:107], a[20:23], v[112:115]
    v_perm_b32 v100, v186, v186, v8
    v_perm_b32 v101, v186, v186, v9
    v_perm_b32 v102, v186, v186, v10
    v_perm_b32 v103, v186, v186, v11
    v_perm_b32 v104, v186, v186, v12
    v_perm_b32 v105, v186, v186, v13
    v_perm_b32 v106, v186, v186, v14
    v_perm_b32 v107, v186, v186, v15
    v_perm_b32 v68, v160, v160, v8
    v_perm_b32 v69, v160, v160, v9
    v_perm_b32 v70, v160, v160, v10
    v_perm_b32 v71, v160, v160, v11
    v_perm_b32 v72, v160, v160, v12
    v_perm_b32 v73, v160, v160, v13
    v_perm_b32 v74, v160, v160, v14
    v_perm_b32 v75, v160, v160, v15
    v_perm_b32 v76, v161, v161, v8
    v_perm_b32 v77, v161, v161, v9
    v_perm_b32 v78, v161, v161, v10
    v_perm_b32 v79, v161, v161, v11
    v_perm_b32 v80, v161, v161, v12
    v_perm_b32 v81, v161, v161, v13
    v_perm_b32 v82, v161, v161, v14
    v_perm_b32 v83, v161, v161, v15
    s_cbranch_vccnz L_s271
L_b271:
    s_waitcnt vmcnt(8)
    buffer_load_dwordx4 a[60:63], v4, s[32:35], s72 offen offset:3072 nt
    v_mfma_f32_16x16x32_bf16 v[108:111], v[100:103], a[24:27], v[108:111]
    v_mfma_f32_16x16x32_bf16 v[112:115], v[104:107], a[24:27], v[112:115]
    v_perm_b32 v100, v187, v187, v8
    v_perm_b32 v101, v187, v187, v9
    v_perm_b32 v102, v187, v187, v10
    v_perm_b32 v103, v187, v187, v11
    v_perm_b32 v104, v187, v187, v12
    v_perm_b32 v105, v187, v187, v13
    v_perm_b32 v106, v187, v187, v14
    v_perm_b32 v107, v187, v187, v15
    v_perm_b32 v84, v162, v162, v8
    v_perm_b32 v85, v162, v162, v9
    v_perm_b32 v86, v162, v162, v10
    v_perm_b32 v87, v162, v162, v11
    v_perm_b32 v88, v162, v162, v12
    v_perm_b32 v89, v162, v162, v13
    v_perm_b32 v90, v162, v162, v14
    v_perm_b32 v91, v162, v162, v15
    v_perm_b32 v92, v163, v163, v8
    v_perm_b32 v93, v163, v163, v9
    v_perm_b32 v94, v163, v163, v10
    v_perm_b32 v95, v163, v163, v11
    v_perm_b32 v96, v163, v163, v12
    v_perm_b32 v97, v163, v163, v13
    v_perm_b32 v98, v163, v163, v14
    v_perm_b32 v99, v163, v163, v15
    s_add_u32 m0, s45, 0
    s_nop 0
    buffer_load_dwordx4 v240, s[48:51], s44 offen nt lds
    s_add_u32 s44, s44, 8192
    s_add_u32 m0, s45, 1024
    s_nop 0
    buffer_load_dwordx4 v244, s[48:51], s44 offen nt lds
    s_add_u32 s44, s44, 8192
    s_add_u32 m0, s45, 2048
    s_nop 0
    buffer_load_dwordx4 v240, s[48:51], s44 offen nt lds
    s_add_u32 s44, s44, 8192
    s_add_u32 m0, s45, 3072
    s_nop 0
    buffer_load_dwordx4 v244, s[48:51], s44 offen nt lds
    s_add_u32 s44, s44, 8192
    s_waitcnt vmcnt(12)
    v_mfma_f32_16x16x32_bf16 v[108:111], v[100:103], a[28:31], v[108:111]
    v_mfma_f32_16x16x32_bf16 v[112:115], v[104:107], a[28:31], v[112:115]
    s_waitcnt vmcnt(11)
    v_mfma_f32_16x16x32_bf16 v[108:111], v[32:35], a[32:35], v[108:111]
    v_mfma_f32_16x16x32_bf16 v[112:115], v[36:39], a[32:35], v[112:115]
    s_waitcnt vmcnt(10)
    v_mfma_f32_16x16x32_bf16 v[108:111], v[40:43], a[36:39], v[108:111]
    v_mfma_f32_16x16x32_bf16 v[112:115], v[44:47], a[36:39], v[112:115]
    s_waitcnt vmcnt(9)
    v_mfma_f32_16x16x32_bf16 v[108:111], v[48:51], a[40:43], v[108:111]
    v_mfma_f32_16x16x32_bf16 v[112:115], v[52:55], a[40:43], v[112:115]
    s_waitcnt vmcnt(8)
    v_mfma_f32_16x16x32_bf16 v[108:111], v[56:59], a[44:47], v[108:111]
    v_mfma_f32_16x16x32_bf16 v[112:115], v[60:63], a[44:47], v[112:115]
    s_waitcnt vmcnt(7)
    v_mfma_f32_16x16x32_bf16 v[108:111], v[68:71], a[48:51], v[108:111]
    v_mfma_f32_16x16x32_bf16 v[112:115], v[72:75], a[48:51], v[112:115]
    s_waitcnt vmcnt(6)
    v_mfma_f32_16x16x32_bf16 v[108:111], v[76:79], a[52:55], v[108:111]
    v_mfma_f32_16x16x32_bf16 v[112:115], v[80:83], a[52:55], v[112:115]
    s_waitcnt vmcnt(5)
    v_mfma_f32_16x16x32_bf16 v[108:111], v[84:87], a[56:59], v[108:111]
    v_mfma_f32_16x16x32_bf16 v[112:115], v[88:91], a[56:59], v[112:115]
    s_waitcnt vmcnt(4)
    v_mfma_f32_16x16x32_bf16 v[108:111], v[92:95], a[60:63], v[108:111]
    v_mfma_f32_16x16x32_bf16 v[112:115], v[96:99], a[60:63], v[112:115]
L_tail:
    s_nop 6
    v_pk_mul_f32 v[108:109], v[108:109], v[122:123] op_sel_hi:[1,0]
    v_pk_mul_f32 v[110:111], v[110:111], v[122:123] op_sel_hi:[1,0]
    ds_write_b128 v232, v[108:111]
    v_pk_mul_f32 v[112:113], v[112:113], v[122:123] op_sel:[0,1]
    v_pk_mul_f32 v[114:115], v[114:115], v[122:123] op_sel:[0,1]
    ds_write_b128 v232, v[112:115] offset:1024
    s_waitcnt lgkmcnt(0)
    s_barrier
    ds_read2st64_b64 v[88:91], v233 offset0:0 offset1:4
    ds_read2st64_b64 v[92:95], v233 offset0:8 offset1:12
    s_waitcnt lgkmcnt(1)
    v_pk_add_f32 v[88:89], v[88:89], v[90:91]
    s_waitcnt lgkmcnt(0)
    v_pk_add_f32 v[92:93], v[92:93], v[94:95]
    v_pk_add_f32 v[88:89], v[88:89], v[92:93]
    v_bfi_b32 v88, v251, v7, v88
    s_cmp_eq_u32 s96, 0
    s_cbranch_scc1 L_ls5
    buffer_store_dwordx2 v[88:89], v235, s[36:39], s13 offen
L_le5:
    v_mov_b32 v140, 0
    ds_write_b32 v234, v140 offset:12544
    s_cmp_eq_u32 s100, 0
    s_cbranch_scc1 L_t3
    buffer_load_dwordx4 v[176:179], v4, s[36:39], s14 offen offset:0 sc1
    buffer_load_dwordx4 v[180:183], v4, s[36:39], s14 offen offset:1024 sc1
    buffer_load_dwordx4 v[184:187], v4, s[36:39], s14 offen offset:2048 sc1
    buffer_load_dwordx4 v[188:191], v4, s[36:39], s14 offen offset:3072 sc1
    s_and_b32 s7, s6, 1
    s_bfe_u32 s9, s6, 0x10001
    s_lshl_b32 s9, s9, 16
    s_or_b32 s7, s7, s9
    v_mov_b32 v240, s7
    s_mov_b32 s30, 0x10001
    s_and_b32 s31, s2, 7
    s_lshl_b32 s31, s31, 14
    s_add_u32 s31, s31, 1310720
    s_waitcnt vmcnt(5)
    s_barrier
    ds_read_b64_tr_b16 v[144:145], v143 offset:0
    ds_read_b64_tr_b16 v[146:147], v143 offset:512
    ds_read_b64_tr_b16 v[148:149], v143 offset:4096
    ds_read_b64_tr_b16 v[150:151], v143 offset:4608
    ds_read_b64_tr_b16 v[152:153], v143 offset:8192
    ds_read_b64_tr_b16 v[154:155], v143 offset:8704
    ds_read_b64_tr_b16 v[156:157], v143 offset:12288
    ds_read_b64_tr_b16 v[158:159], v143 offset:12800
    ds_read_b64_tr_b16 v[160:161], v143 offset:16384
    ds_read_b64_tr_b16 v[162:163], v143 offset:16896
    ds_read_b64_tr_b16 v[164:165], v143 offset:20480
    ds_read_b64_tr_b16 v[166:167], v143 offset:20992
    s_waitcnt lgkmcnt(8)
    ds_read_b64_tr_b16 v[168:169], v143 offset:24576
    ds_read_b64_tr_b16 v[170:171], v143 offset:25088
    ds_read_b64_tr_b16 v[172:173], v143 offset:28672
    ds_read_b64_tr_b16 v[174:175], v143 offset:29184
    s_xor_b32 s17, s23, 65536
L_t1s:
    s_branch L_t1b
L_t1:
    s_add_u32 s74, s74, 1
    s_cmp_lt_u32 s74, 200000
    s_cbranch_scc0 L_t1ok
    buffer_load_dwordx4 v[176:179], v4, s[36:39], s14 offen offset:0 sc1
    buffer_load_dwordx4 v[180:183], v4, s[36:39], s14 offen offset:1024 sc1
    buffer_load_dwordx4 v[184:187], v4, s[36:39], s14 offen offset:2048 sc1
    buffer_load_dwordx4 v[188:191], v4, s[36:39], s14 offen offset:3072 sc1
L_t1b:
    s_waitcnt vmcnt(2)
    v_xor_b32 v176, v176, v250
    v_xor_b32 v180, v180, v250
    v_pk_add_f32 v[98:99], v[178:179], v[182:183]
    v_pk_add_f32 v[96:97], v[176:177], v[180:181]
    v_or_b32 v125, v176, v180
    s_waitcnt vmcnt(0)
    v_xor_b32 v184, v184, v250
    v_xor_b32 v188, v188, v250
    v_or3_b32 v125, v125, v184, v188
    v_cmp_ne_u32_sdwa vcc, v125, v140 src0_sel:BYTE_0 src1_sel:DWORD
    v_pk_add_f32 v[100:101], v[184:185], v[188:189]
    v_pk_add_f32 v[102:103], v[186:187], v[190:191]
    s_cbranch_vccnz L_t1
L_t1ok:
    v_pk_add_f32 v[96:97], v[96:97], v[100:101]
    v_pk_add_f32 v[98:99], v[98:99], v[102:103]
    v_cvt_pk_bf16_f32 v96, v96, v97
    v_cvt_pk_bf16_f32 v97, v98, v99
    ds_write_b64 v236, v[96:97] offset:8448
    s_waitcnt lgkmcnt(0)
    s_barrier
    ds_read_b128 v[8:11], v237 offset:0
    ds_read_b128 v[12:15], v237 offset:64
    ds_read_b128 v[16:19], v237 offset:128
    ds_read_b128 v[20:23], v237 offset:192
    s_cmp_eq_u32 s73, 2
    s_waitcnt lgkmcnt(2)
    v_mfma_f32_16x16x32_bf16 v[92:95], v[144:147], v[8:11], 0
    v_mfma_f32_16x16x32_bf16 v[92:95], v[148:151], v[12:15], v[92:95]
    s_waitcnt lgkmcnt(0)
    v_mfma_f32_16x16x32_bf16 v[92:95], v[152:155], v[16:19], v[92:95]
    v_mfma_f32_16x16x32_bf16 v[92:95], v[156:159], v[20:23], v[92:95]
    v_mfma_f32_16x16x32_bf16 v[100:103], v[160:163], v[8:11], 0
    v_mfma_f32_16x16x32_bf16 v[100:103], v[164:167], v[12:15], v[100:103]
    v_mfma_f32_16x16x32_bf16 v[100:103], v[168:171], v[16:19], v[100:103]
    v_mfma_f32_16x16x32_bf16 v[100:103], v[172:175], v[20:23], v[100:103]
    s_nop 3
    v_cvt_pk_bf16_f32 v90, v92, v93
    v_cvt_pk_bf16_f32 v91, v94, v95
    v_bfi_b32 v90, s30, v240, v90
    buffer_store_dwordx2 v[90:91], v239, s[36:39], s23 offen sc1
    s_cbranch_scc0 L_t1one
    v_cvt_pk_bf16_f32 v92, v100, v101
    v_cvt_pk_bf16_f32 v93, v102, v103
    v_bfi_b32 v92, s30, v240, v92
    buffer_store_dwordx2 v[92:93], v239, s[36:39], s17 offen sc1
    s_branch L_t5s
L_t1one:
    s_lshr_b32 s8, s2, 5
    s_lshl_b32 s8, s8, 3
    s_and_b32 s0, s100, 2
    s_lshl_b32 s0, s0, 1
    s_add_u32 s8, s8, s0
    s_add_u32 s8, s8, s3
    s_lshl_b32 s17, s8, 12
    s_add_u32 s17, s17, 1048576
    s_lshl_b32 s18, s8, 8
    s_add_u32 s18, s18, s31
    s_mov_b32 s32, 0
    s_mov_b32 s33, -1
    v_and_b32 v241, 7, v0
    v_lshlrev_b32 v241, 4, v241
    v_bfe_u32 v125, v0, 3, 1
    v_lshl_or_b32 v241, v125, 2, v241
    v_bfe_u32 v125, v0, 5, 1
    v_lshl_or_b32 v241, v125, 3, v241
    v_bfe_u32 v125, v0, 4, 1
    v_lshl_or_b32 v241, v125, 7, v241
    v_lshlrev_b32 v124, 16, v124
    v_xor_b32 v127, s30, v240
    v_cndmask_b32 v246, v240, v127, s[78:79]
    v_and_b32 v127, 1, v0
    v_lshlrev_b32 v127, 4, v127
    v_mov_b32 v128, 0x3f80
    v_lshlrev_b32 v128, v127, v128
    v_bfe_u32 v126, v0, 1, 2
    v_cmp_eq_u32 vcc, 0, v126
    s_nop 1
    v_cndmask_b32 v108, 0, v128, vcc
    v_cmp_eq_u32 vcc, 1, v126
    s_nop 1
    v_cndmask_b32 v109, 0, v128, vcc
    v_cmp_eq_u32 vcc, 2, v126
    s_nop 1
    v_cndmask_b32 v110, 0, v128, vcc
    v_cmp_eq_u32 vcc, 3, v126
    s_nop 1
    v_cndmask_b32 v111, 0, v128, vcc
    s_waitcnt vmcnt(0)
L_r:
    s_add_u32 s74, s74, 1
    s_cmp_lt_u32 s74, 200000
    s_cbranch_scc0 L_rok
    buffer_load_dwordx4 v[176:179], v4, s[36:39], s17 offen offset:0 sc1
    buffer_load_dwordx4 v[180:183], v4, s[36:39], s17 offen offset:1024 sc1
    buffer_load_dwordx4 v[184:187], v4, s[36:39], s17 offen offset:2048 sc1
    buffer_load_dwordx4 v[188:191], v4, s[36:39], s17 offen offset:3072 sc1
L_rb:
    s_waitcnt vmcnt(2)
    v_bitop3_b32 v125, v176, v178, v240 bitop3:0x7e
    v_xor_b32 v176, v176, v246
    v_xor_b32 v178, v178, v246
    v_bitop3_b32 v126, v180, v182, v240 bitop3:0x7e
    v_xor_b32 v180, v180, v246
    v_xor_b32 v182, v182, v246
    v_mfma_f32_16x16x32_bf16 v[96:99], v[108:111], v[176:179], 0
    s_waitcnt vmcnt(0)
    v_bitop3_b32 v127, v184, v186, v240 bitop3:0x7e
    v_xor_b32 v184, v184, v246
    v_xor_b32 v186, v186, v246
    v_mfma_f32_16x16x32_bf16 v[96:99], v[108:111], v[180:183], v[96:99]
    v_bitop3_b32 v128, v188, v190, v240 bitop3:0x7e
    v_xor_b32 v188, v188, v246
    v_xor_b32 v190, v190, v246
    v_mfma_f32_16x16x32_bf16 v[96:99], v[108:111], v[184:187], v[96:99]
    v_or3_b32 v125, v125, v126, v127
    v_mfma_f32_16x16x32_bf16 v[96:99], v[108:111], v[188:191], v[96:99]
    v_bitop3_b32 v125, v125, v128, s30 bitop3:0xa8
    v_cmp_ne_u32 vcc, 0, v125
    s_cbranch_vccnz L_r
L_rok:
    s_nop 4
    v_cndmask_b32 v96, v96, v98, s[32:33]
    v_cndmask_b32 v97, v97, v99, s[32:33]
    v_cndmask_b32 v98, v97, v96, s[78:79]
    v_cndmask_b32 v96, v96, v97, s[78:79]
    s_nop 1
    v_add_f32_dpp v96, v98, v96 row_ror:8 row_mask:0xf bank_mask:0xf
    v_cvt_pk_bf16_f32 v96, v96, v96
    v_and_b32 v96, s5, v96
    v_add_f32 v96, v96, v124
    v_cvt_pk_bf16_f32 v96, v96, v96
    v_bfi_b32 v96, s5, v96, v7
    s_cmp_eq_u32 s96, 0
    s_cbranch_scc1 L_ls6
    buffer_store_dword v96, v241, s[36:39], s18 offen
L_le6:
    s_cmp_lg_u32 s3, 0
    s_cbranch_scc1 L_fin
    s_cmp_lg_u32 s99, 1
    s_cbranch_scc1 L_fin
    v_mov_b32 v98, 262144
    s_mov_b64 exec, 1
    buffer_store_dword v7, v98, s[36:39], 0 offen sc1
    s_mov_b64 exec, -1
    s_branch L_fin
L_t5s:
    s_cmp_lg_u32 s3, 0
    s_cbranch_scc1 L_fin
    s_mov_b32 s64, s18
    s_and_b32 s65, s19, 0xffff
    s_mov_b32 s66, 8192
    s_mov_b32 s67, 0x20000
    s_and_b32 s8, s2, 7
    s_lshr_b32 s7, s2, 5
    s_lshl3_add_u32 s8, s8, s7
    s_mul_i32 s17, s8, 7168
    s_add_u32 s17, s17, 2146304
    s_add_u32 s18, s17, 4096
    buffer_load_dwordx4 v[176:179], v4, s[36:39], s17 offen offset:0 sc1
    buffer_load_dwordx4 v[180:183], v4, s[36:39], s17 offen offset:1024 sc1
    buffer_load_dwordx4 v[184:187], v4, s[36:39], s17 offen offset:2048 sc1
    buffer_load_dwordx4 v[188:191], v4, s[36:39], s17 offen offset:3072 sc1
    buffer_load_dwordx4 v[192:195], v4, s[36:39], s18 offen offset:0 sc1
    buffer_load_dwordx4 v[196:199], v4, s[36:39], s18 offen offset:1024 sc1
    buffer_load_dwordx4 v[200:203], v4, s[36:39], s18 offen offset:2048 sc1
    v_xor_b32 v127, s30, v240
    v_cndmask_b32 v246, v240, v127, s[78:79]
    v_and_b32 v127, 1, v0
    v_lshlrev_b32 v127, 4, v127
    v_mov_b32 v128, 0x3f80
    v_lshlrev_b32 v128, v127, v128
    v_bfe_u32 v126, v0, 1, 2
    v_cmp_eq_u32 vcc, 0, v126
    s_nop 1
    v_cndmask_b32 v108, 0, v128, vcc
    v_cmp_eq_u32 vcc, 1, v126
    s_nop 1
    v_cndmask_b32 v109, 0, v128, vcc
    v_cmp_eq_u32 vcc, 2, v126
    s_nop 1
    v_cndmask_b32 v110, 0, v128, vcc
    v_cmp_eq_u32 vcc, 3, v126
    s_nop 1
    v_cndmask_b32 v111, 0, v128, vcc
    s_lshl_b32 s20, s8, 4
    s_lshl_b32 s19, s8, 8
    s_add_u32 s19, s19, s31
    s_mov_b32 s32, 0
    s_mov_b32 s33, -1
    v_and_b32 v125, 7, v0
    v_lshlrev_b32 v243, 4, v125
    v_lshlrev_b32 v242, 10, v125
    v_bfe_u32 v125, v0, 3, 1
    v_lshl_or_b32 v243, v125, 2, v243
    v_lshl_or_b32 v242, v125, 1, v242
    v_bfe_u32 v125, v0, 5, 1
    v_lshl_or_b32 v243, v125, 3, v243
    v_lshl_or_b32 v242, v125, 2, v242
    v_bfe_u32 v125, v0, 4, 1
    v_lshl_or_b32 v243, v125, 7, v243
    v_lshl_or_b32 v242, v125, 3, v242
L_t5h:
    buffer_load_dword v104, v243, s[36:39], s19 offen sc1
    s_waitcnt vmcnt(0)
    v_xor_b32 v125, v104, v7
    v_cmp_ne_u32_sdwa vcc, v125, v140 src0_sel:WORD_0 src1_sel:DWORD
    s_cbranch_vccz L_t5hok
    s_add_u32 s74, s74, 1
    s_cmp_lt_u32 s74, 200000
    s_cbranch_scc1 L_t5h
L_t5hok:
    v_and_b32 v104, s5, v104
L_t5:
    s_add_u32 s74, s74, 1
    s_cmp_lt_u32 s74, 200000
    s_cbranch_scc0 L_t5ok
    buffer_load_dwordx4 v[176:179], v4, s[36:39], s17 offen offset:0 sc1
    buffer_load_dwordx4 v[180:183], v4, s[36:39], s17 offen offset:1024 sc1
    buffer_load_dwordx4 v[184:187], v4, s[36:39], s17 offen offset:2048 sc1
    buffer_load_dwordx4 v[188:191], v4, s[36:39], s17 offen offset:3072 sc1
    buffer_load_dwordx4 v[192:195], v4, s[36:39], s18 offen offset:0 sc1
    buffer_load_dwordx4 v[196:199], v4, s[36:39], s18 offen offset:1024 sc1
    buffer_load_dwordx4 v[200:203], v4, s[36:39], s18 offen offset:2048 sc1
L_t5b:
    s_waitcnt vmcnt(6)
    v_bitop3_b32 v125, v176, v178, v240 bitop3:0x7e
    v_xor_b32 v176, v176, v246
    v_xor_b32 v178, v178, v246
    s_waitcnt vmcnt(5)
    v_bitop3_b32 v126, v180, v182, v240 bitop3:0x7e
    v_xor_b32 v180, v180, v246
    v_xor_b32 v182, v182, v246
    v_mfma_f32_16x16x32_bf16 v[96:99], v[108:111], v[176:179], 0
    s_waitcnt vmcnt(4)
    v_bitop3_b32 v127, v184, v186, v240 bitop3:0x7e
    v_xor_b32 v184, v184, v246
    v_xor_b32 v186, v186, v246
    v_mfma_f32_16x16x32_bf16 v[96:99], v[108:111], v[180:183], v[96:99]
    v_or3_b32 v125, v125, v126, v127
    s_waitcnt vmcnt(3)
    v_bitop3_b32 v128, v188, v190, v240 bitop3:0x7e
    v_xor_b32 v188, v188, v246
    v_xor_b32 v190, v190, v246
    v_mfma_f32_16x16x32_bf16 v[96:99], v[108:111], v[184:187], v[96:99]
    s_waitcnt vmcnt(2)
    v_bitop3_b32 v129, v192, v194, v240 bitop3:0x7e
    v_xor_b32 v192, v192, v246
    v_xor_b32 v194, v194, v246
    v_mfma_f32_16x16x32_bf16 v[96:99], v[108:111], v[188:191], v[96:99]
    v_or3_b32 v125, v125, v128, v129
    s_waitcnt vmcnt(1)
    v_bitop3_b32 v130, v196, v198, v240 bitop3:0x7e
    v_xor_b32 v196, v196, v246
    v_xor_b32 v198, v198, v246
    v_mfma_f32_16x16x32_bf16 v[96:99], v[108:111], v[192:195], v[96:99]
    s_waitcnt vmcnt(0)
    v_bitop3_b32 v131, v200, v202, v240 bitop3:0x7e
    v_xor_b32 v200, v200, v246
    v_xor_b32 v202, v202, v246
    v_mfma_f32_16x16x32_bf16 v[96:99], v[108:111], v[196:199], v[96:99]
    v_or_b32 v125, v125, v130
    v_mfma_f32_16x16x32_bf16 v[96:99], v[108:111], v[200:203], v[96:99]
    v_bitop3_b32 v125, v125, v131, s30 bitop3:0xa8
    v_cmp_ne_u32 vcc, 0, v125
    s_cbranch_vccnz L_t5
L_t5ok:
    s_nop 4
    v_cndmask_b32 v96, v96, v98, s[32:33]
    v_cndmask_b32 v97, v97, v99, s[32:33]
    v_cndmask_b32 v98, v97, v96, s[78:79]
    v_cndmask_b32 v96, v96, v97, s[78:79]
    s_nop 1
    v_add_f32_dpp v96, v98, v96 row_ror:8 row_mask:0xf bank_mask:0xf
    v_cvt_pk_bf16_f32 v96, v96, v96
    v_and_b32 v96, s5, v96
    v_add_f32 v96, v96, v104
    v_cvt_pk_bf16_f32 v96, v96, v96
    buffer_store_short v96, v242, s[64:67], s20 offen
    s_branch L_fin
L_t3:
    s_cmp_eq_u32 s73, 0
    s_cbranch_scc1 L_fin
    s_waitcnt vmcnt(4)
    s_add_u32 m0, s47, 2048
    s_nop 0
    buffer_load_dwordx4 v224, s[52:55], s46 offen  lds
    s_waitcnt vmcnt(4)
    s_add_u32 m0, s47, 10240
    s_nop 0
    buffer_load_dwordx4 v225, s[56:59], s46 offen  lds
    s_add_u32 s46, s46, 57344
    s_waitcnt vmcnt(4)
    s_add_u32 m0, s47, 3072
    s_nop 0
    buffer_load_dwordx4 v224, s[52:55], s46 offen  lds
    s_waitcnt vmcnt(4)
    s_add_u32 m0, s47, 11264
    s_nop 0
    buffer_load_dwordx4 v225, s[56:59], s46 offen  lds
    s_add_u32 s46, s46, 57344
    s_waitcnt vmcnt(4)
    s_add_u32 m0, s47, 4096
    s_nop 0
    buffer_load_dwordx4 v224, s[52:55], s46 offen  lds
    s_and_b32 s7, s6, 1
    s_bfe_u32 s9, s6, 0x10001
    s_lshl_b32 s9, s9, 16
    s_or_b32 s7, s7, s9
    v_mov_b32 v240, s7
    s_mov_b32 s30, 0x10001
    s_and_b32 s31, s2, 7
    s_lshl_b32 s31, s31, 14
    s_add_u32 s31, s31, 1310720
    v_lshrrev_b32 v125, 2, v141
    v_lshl_add_u32 v125, v142, 3, v125
    v_lshlrev_b32 v248, 8, v125
    v_lshlrev_b32 v125, 6, v125
    v_bfe_u32 v126, v0, 1, 1
    v_lshl_add_u32 v125, v126, 13, v125
    v_bfe_u32 v127, v0, 4, 1
    v_lshl_or_b32 v126, v127, 1, v126
    v_xor_b32 v126, s3, v126
    v_lshl_add_u32 v125, v126, 4, v125
    v_and_b32 v126, 1, v0
    v_lshl_add_u32 v125, v126, 3, v125
    v_add_u32 v134, 43264, v125
    v_and_b32 v126, 1, v0
    v_lshl_or_b32 v248, v126, 4, v248
    v_bfe_u32 v126, v0, 2, 3
    v_bfe_u32 v127, v0, 1, 1
    v_xor_b32 v126, v126, v127
    v_lshl_or_b32 v248, v126, 5, v248
    s_lshl_b32 s45, s3, 13
    s_add_u32 s45, s45, 108800
    v_and_b32 v125, 7, v0
    v_bfe_u32 v126, v0, 3, 1
    v_mul_u32_u24 v242, 1056, v125
    v_and_b32 v127, 56, v0
    v_add_u32 v241, v242, v127
    s_lshl_b32 s7, s3, 8
    v_add_u32 v241, s7, v241
    v_lshl_add_u32 v242, v142, 4, v242
    v_mul_u32_u24 v244, 80, v125
    v_lshl_add_u32 v243, v142, 2, v244
    s_lshl_b32 s7, s3, 4
    v_add_u32 v243, s7, v243
    v_lshlrev_b32 v245, 6, v125
    v_lshl_or_b32 v128, v142, 4, v245
    v_lshl_or_b32 v245, v126, 2, v245
    v_bfe_u32 v127, v0, 4, 1
    v_lshl_or_b32 v245, v127, 3, v245
    v_bfe_u32 v127, v0, 5, 1
    v_lshl_or_b32 v245, v127, 1, v245
    s_lshl_b32 s7, s3, 4
    v_add_u32 v245, s7, v245
    v_lshl_add_u32 v247, v126, 2, v142
    v_mul_u32_u24 v247, 7168, v247
    v_lshl_add_u32 v247, v125, 4, v247
    s_mul_i32 s18, s3, 114688
    s_lshl_b32 s7, s10, 7
    s_add_u32 s18, s18, s7
    s_add_u32 s18, s18, 2146304
    s_add_u32 s20, s18, 57344
    v_add_u32 v128, 17408, v128
    v_mov_b32 v129, 12544
    v_cndmask_b32 v249, v128, v129, s[78:79]
    v_cndmask_b32 v238, v129, v128, s[78:79]
    s_lshl_b32 s17, s3, 12
    s_add_u32 s17, s17, s31
    s_mov_b32 s28, 0x07060302
    s_mov_b32 s29, 0x3f803f80
    s_mov_b32 s19, 0
    v_mov_b32 v96, s29
    v_mov_b32 v97, s29
    v_mov_b32 v98, s29
    v_mov_b32 v99, s29
    v_mov_b32 v100, s29
    v_mov_b32 v101, s29
    v_mov_b32 v102, s29
    v_mov_b32 v103, s29
    s_branch L_t3lok
L_t3s:
L_t3l:
    s_add_u32 s74, s74, 1
    s_cmp_lt_u32 s74, 200000
    s_cbranch_scc0 L_t3lok
    buffer_load_dwordx4 v[176:179], v4, s[36:39], s17 offen offset:0 sc1
    buffer_load_dwordx4 v[180:183], v4, s[36:39], s17 offen offset:1024 sc1
    buffer_load_dwordx4 v[184:187], v4, s[36:39], s17 offen offset:2048 sc1
    buffer_load_dwordx4 v[188:191], v4, s[36:39], s17 offen offset:3072 sc1
L_t3lb:
    s_waitcnt vmcnt(2)
    v_bitop3_b32 v125, v176, v180, v7 bitop3:0x7e
    v_perm_b32 v96, v177, v176, s28
    v_perm_b32 v97, v179, v178, s28
    v_perm_b32 v98, v181, v180, s28
    v_perm_b32 v99, v183, v182, s28
    v_dot2_f32_bf16 v120, v96, s29, 0
    v_dot2_f32_bf16 v121, v96, v96, 0
    v_dot2_f32_bf16 v120, v97, s29, v120
    v_dot2_f32_bf16 v121, v97, v97, v121
    v_dot2_f32_bf16 v120, v98, s29, v120
    v_dot2_f32_bf16 v121, v98, v98, v121
    v_dot2_f32_bf16 v120, v99, s29, v120
    v_dot2_f32_bf16 v121, v99, v99, v121
    s_waitcnt vmcnt(0)
    v_bitop3_b32 v126, v184, v188, v7 bitop3:0x7e
    v_or_b32 v125, v125, v126
    v_cmp_ne_u32_sdwa vcc, v125, v140 src0_sel:WORD_0 src1_sel:DWORD
    v_perm_b32 v100, v185, v184, s28
    v_perm_b32 v101, v187, v186, s28
    v_perm_b32 v102, v189, v188, s28
    v_perm_b32 v103, v191, v190, s28
    s_cbranch_vccnz L_t3l
L_t3lok:
    ds_write_b64 v241, v[96:97] offset:26880
    ds_write_b64 v241, v[98:99] offset:26944
    ds_write_b64 v241, v[100:101] offset:27008
    ds_write_b64 v241, v[102:103] offset:27072
    v_dot2_f32_bf16 v120, v100, s29, v120
    v_dot2_f32_bf16 v121, v100, v100, v121
    v_dot2_f32_bf16 v120, v101, s29, v120
    v_dot2_f32_bf16 v121, v101, v101, v121
    v_dot2_f32_bf16 v120, v102, s29, v120
    v_dot2_f32_bf16 v121, v102, v102, v121
    v_dot2_f32_bf16 v120, v103, s29, v120
    v_dot2_f32_bf16 v121, v103, v103, v121
    s_nop 2
    v_permlane16_swap_b32 v120, v121
    v_add_f32 v120, v120, v121
    s_nop 1
    v_add_f32_dpp v120, v120, v120 row_ror:8 row_mask:0xf bank_mask:0xf
    ds_write_b32 v243, v120 offset:16640
    s_waitcnt lgkmcnt(0)
    s_barrier
    ds_read_b128 v[8:11], v242 offset:26880
    ds_read_b128 v[12:15], v242 offset:26944
    ds_read_b128 v[72:75], v244 offset:16640
    ds_read_b128 v[76:79], v244 offset:16656
    ds_read_b128 v[80:83], v244 offset:16672
    ds_read_b128 v[84:87], v244 offset:16688
    ds_read_b128 v[16:19], v242 offset:27008
    ds_read_b128 v[20:23], v242 offset:27072
    ds_read_b128 v[24:27], v242 offset:27136
    ds_read_b128 v[28:31], v242 offset:27200
    ds_read_b128 v[32:35], v242 offset:27264
    ds_read_b128 v[36:39], v242 offset:27328
    ds_read_b128 v[40:43], v242 offset:27392
    ds_read_b128 v[44:47], v242 offset:27456
    s_waitcnt lgkmcnt(12)
    v_mfma_f32_16x16x32_bf16 v[144:147], a[128:131], v[8:11], 0
    ds_read_b128 v[48:51], v242 offset:27520
    v_mfma_f32_16x16x32_bf16 v[144:147], a[132:135], v[12:15], v[144:147]
    ds_read_b128 v[52:55], v242 offset:27584
    s_waitcnt lgkmcnt(6)
    v_mfma_f32_16x16x32_bf16 v[144:147], a[136:139], v[16:19], v[144:147]
    ds_read_b128 v[56:59], v242 offset:27648
    v_pk_add_f32 v[72:73], v[72:73], v[74:75]
    v_mfma_f32_16x16x32_bf16 v[144:147], a[140:143], v[20:23], v[144:147]
    ds_read_b128 v[60:63], v242 offset:27712
    v_pk_add_f32 v[76:77], v[76:77], v[78:79]
    v_mfma_f32_16x16x32_bf16 v[144:147], a[144:147], v[24:27], v[144:147]
    ds_read_b128 v[64:67], v242 offset:27776
    v_pk_add_f32 v[80:81], v[80:81], v[82:83]
    v_mfma_f32_16x16x32_bf16 v[144:147], a[148:151], v[28:31], v[144:147]
    ds_read_b128 v[68:71], v242 offset:27840
    v_pk_add_f32 v[84:85], v[84:85], v[86:87]
    s_waitcnt lgkmcnt(6)
    v_mfma_f32_16x16x32_bf16 v[144:147], a[152:155], v[32:35], v[144:147]
    v_pk_add_f32 v[72:73], v[72:73], v[76:77]
    v_pk_add_f32 v[80:81], v[80:81], v[84:85]
    v_mfma_f32_16x16x32_bf16 v[144:147], a[156:159], v[36:39], v[144:147]
    v_pk_add_f32 v[72:73], v[72:73], v[80:81]
    v_mul_f32 v127, 0x3b000000, v72
    v_mfma_f32_16x16x32_bf16 v[144:147], a[160:163], v[40:43], v[144:147]
    v_mul_f32 v125, 0x3b000000, v73
    v_fma_f32 v125, -v127, v127, v125
    v_mfma_f32_16x16x32_bf16 v[144:147], a[164:167], v[44:47], v[144:147]
    v_max_f32 v125, 0, v125
    v_cvt_pk_bf16_f32 v129, v127, v125
    s_waitcnt lgkmcnt(3)
    v_mfma_f32_16x16x32_bf16 v[144:147], a[168:171], v[48:51], v[144:147]
    v_lshlrev_b32 v128, 16, v129
    v_and_b32 v129, s5, v129
    v_mfma_f32_16x16x32_bf16 v[144:147], a[172:175], v[52:55], v[144:147]
    v_add_f32 v129, 0x3727c5ac, v129
    v_cvt_pk_bf16_f32 v129, v129, v129
    v_mfma_f32_16x16x32_bf16 v[144:147], a[176:179], v[56:59], v[144:147]
    v_lshlrev_b32 v129, 16, v129
    v_sqrt_f32 v129, v129
    s_waitcnt lgkmcnt(0)
    v_mfma_f32_16x16x32_bf16 v[144:147], a[180:183], v[60:63], v[144:147]
    v_cvt_pk_bf16_f32 v129, v129, v129
    v_lshlrev_b32 v129, 16, v129
    v_mfma_f32_16x16x32_bf16 v[144:147], a[184:187], v[64:67], v[144:147]
    v_rcp_f32 v129, v129
    s_nop 0
    v_mul_f32 v128, v128, v129
    v_mfma_f32_16x16x32_bf16 v[144:147], a[188:191], v[68:71], v[144:147]
    v_mul_f32 v130, v128, v116
    v_mul_f32 v131, v128, v117
    v_mov_b32 v126, 0xc0135761
    s_nop 4
    v_permlane32_swap_b32 v144, v145
    v_permlane32_swap_b32 v146, v147
    v_cndmask_b32 v144, v144, v146, s[78:79]
    v_cndmask_b32 v145, v145, v147, s[78:79]
    v_fma_f32 v132, v144, v129, -v130
    v_fma_f32 v133, v145, v129, -v131
    v_cvt_pk_bf16_f32 v133, v132, v133
    v_lshlrev_b32 v132, 16, v133
    v_mul_f32 v125, v132, v132
    v_fmac_f32 v126, 0xbdd2d3e8, v125
    v_mul_f32 v125, v126, v132
    v_exp_f32 v125, v125
    v_and_b32 v133, s5, v133
    v_add_f32 v125, 1.0, v125
    v_rcp_f32 v125, v125
    s_cmp_eq_u32 s19, 0
    v_mul_f32 v125, v125, v132
    v_cvt_pk_bf16_f32 v125, v125, v125
    v_lshlrev_b32 v125, 16, v125
    v_mul_f32 v125, v125, v133
    v_cvt_pk_bf16_f32 v125, v125, v125
    ds_write_b16 v245, v125 offset:17408
    s_cselect_b32 s38, 0, 2605056
    s_waitcnt lgkmcnt(0)
    s_barrier
    ds_read_b128 v[8:11], v249
    ds_read_b128 v[12:15], v238
    s_waitcnt lgkmcnt(0)
    v_mfma_f32_16x16x32_bf16 v[148:151], a[192:195], v[8:11], 0
    v_mfma_f32_16x16x32_bf16 v[148:151], a[196:199], v[12:15], v[148:151]
    v_mfma_f32_16x16x32_bf16 v[152:155], a[200:203], v[8:11], 0
    v_mfma_f32_16x16x32_bf16 v[152:155], a[204:207], v[12:15], v[152:155]
    v_mfma_f32_16x16x32_bf16 v[156:159], a[208:211], v[8:11], 0
    v_mfma_f32_16x16x32_bf16 v[156:159], a[212:215], v[12:15], v[156:159]
    v_mfma_f32_16x16x32_bf16 v[160:163], a[216:219], v[8:11], 0
    v_mfma_f32_16x16x32_bf16 v[160:163], a[220:223], v[12:15], v[160:163]
    s_nop 1
    v_cvt_pk_bf16_f32 v164, v148, v149
    v_cvt_pk_bf16_f32 v165, v150, v151
    v_cvt_pk_bf16_f32 v166, v152, v153
    v_cvt_pk_bf16_f32 v167, v154, v155
    v_bfi_b32 v164, s30, v240, v164
    v_bfi_b32 v166, s30, v240, v166
    buffer_store_dwordx4 v[164:167], v247, s[36:39], s18 offen sc1
    v_cvt_pk_bf16_f32 v168, v156, v157
    v_cvt_pk_bf16_f32 v169, v158, v159
    v_cvt_pk_bf16_f32 v170, v160, v161
    v_cvt_pk_bf16_f32 v171, v162, v163
    v_bfi_b32 v168, s30, v240, v168
    v_bfi_b32 v170, s30, v240, v170
    buffer_store_dwordx4 v[168:171], v247, s[36:39], s20 offen sc1
    s_cbranch_scc0 L_fin
    s_mov_b32 s19, 1
    s_mov_b32 s38, 2605056
    s_waitcnt vmcnt(4)
    s_add_u32 m0, s47, 12288
    s_nop 0
    buffer_load_dwordx4 v225, s[56:59], s46 offen  lds
    s_add_u32 s46, s46, 57344
    s_waitcnt vmcnt(4)
    s_add_u32 m0, s47, 5120
    s_nop 0
    buffer_load_dwordx4 v224, s[52:55], s46 offen  lds
    s_waitcnt vmcnt(4)
    s_add_u32 m0, s47, 13312
    s_nop 0
    buffer_load_dwordx4 v225, s[56:59], s46 offen  lds
    s_add_u32 s46, s46, 57344
    s_waitcnt vmcnt(4)
    s_add_u32 m0, s47, 6144
    s_nop 0
    buffer_load_dwordx4 v224, s[52:55], s46 offen  lds
    s_waitcnt vmcnt(4)
    s_add_u32 m0, s47, 14336
    s_nop 0
    buffer_load_dwordx4 v225, s[56:59], s46 offen  lds
    s_add_u32 s46, s46, 57344
    s_waitcnt vmcnt(4)
    s_add_u32 m0, s47, 7168
    s_nop 0
    buffer_load_dwordx4 v224, s[52:55], s46 offen  lds
    s_waitcnt vmcnt(4)
    s_add_u32 m0, s47, 15360
    s_nop 0
    buffer_load_dwordx4 v225, s[56:59], s46 offen  lds
    s_add_u32 s46, s46, 57344
    s_lshl_b32 s8, s10, 15
    s_lshl_b32 s7, s3, 8
    s_add_u32 s8, s8, s7
    s_add_u32 s8, s8, 0
    s_lshl_b32 s7, s3, 13
    s_add_u32 m0, s7, 108800
    s_waitcnt vmcnt(4)
    buffer_load_dwordx4 v253, s[60:63], s8 offen nt lds
    s_add_u32 s8, s8, 4096
    s_add_u32 m0, m0, 1024
    s_waitcnt vmcnt(4)
    buffer_load_dwordx4 v253, s[60:63], s8 offen nt lds
    s_add_u32 s8, s8, 4096
    s_add_u32 m0, m0, 1024
    s_waitcnt vmcnt(4)
    buffer_load_dwordx4 v254, s[60:63], s8 offen nt lds
    s_add_u32 s8, s8, 4096
    s_add_u32 m0, m0, 1024
    s_waitcnt vmcnt(4)
    buffer_load_dwordx4 v254, s[60:63], s8 offen nt lds
    s_add_u32 s8, s8, 4096
    s_add_u32 m0, m0, 1024
    s_waitcnt vmcnt(4)
    buffer_load_dwordx4 v253, s[60:63], s8 offen nt lds
    s_add_u32 s8, s8, 4096
    s_add_u32 m0, m0, 1024
    s_waitcnt vmcnt(4)
    buffer_load_dwordx4 v253, s[60:63], s8 offen nt lds
    s_add_u32 s8, s8, 4096
    s_add_u32 m0, m0, 1024
    s_waitcnt vmcnt(4)
    buffer_load_dwordx4 v254, s[60:63], s8 offen nt lds
    s_add_u32 s8, s8, 4096
    s_add_u32 m0, m0, 1024
    s_waitcnt vmcnt(4)
    buffer_load_dwordx4 v254, s[60:63], s8 offen nt lds
    s_waitcnt vmcnt(8)
    s_barrier
    ds_read_b64_tr_b16 a[128:129], v134 offset:0
    ds_read_b64_tr_b16 a[130:131], v134 offset:256
    ds_read_b64_tr_b16 a[132:133], v134 offset:2048
    ds_read_b64_tr_b16 a[134:135], v134 offset:2304
    ds_read_b64_tr_b16 a[136:137], v134 offset:4096
    ds_read_b64_tr_b16 a[138:139], v134 offset:4352
    ds_read_b64_tr_b16 a[140:141], v134 offset:6144
    ds_read_b64_tr_b16 a[142:143], v134 offset:6400
    s_waitcnt lgkmcnt(4)
    ds_read_b64_tr_b16 a[144:145], v134 offset:16384
    ds_read_b64_tr_b16 a[146:147], v134 offset:16640
    ds_read_b64_tr_b16 a[148:149], v134 offset:18432
    ds_read_b64_tr_b16 a[150:151], v134 offset:18688
    ds_read_b64_tr_b16 a[152:153], v134 offset:20480
    ds_read_b64_tr_b16 a[154:155], v134 offset:20736
    ds_read_b64_tr_b16 a[156:157], v134 offset:22528
    ds_read_b64_tr_b16 a[158:159], v134 offset:22784
    s_waitcnt lgkmcnt(4)
    ds_read_b64_tr_b16 a[160:161], v134 offset:32768
    ds_read_b64_tr_b16 a[162:163], v134 offset:33024
    ds_read_b64_tr_b16 a[164:165], v134 offset:34816
    ds_read_b64_tr_b16 a[166:167], v134 offset:35072
    ds_read_b64_tr_b16 a[168:169], v134 offset:36864
    ds_read_b64_tr_b16 a[170:171], v134 offset:37120
    ds_read_b64_tr_b16 a[172:173], v134 offset:38912
    ds_read_b64_tr_b16 a[174:175], v134 offset:39168
    s_waitcnt lgkmcnt(4)
    ds_read_b64_tr_b16 a[176:177], v134 offset:49152
    ds_read_b64_tr_b16 a[178:179], v134 offset:49408
    ds_read_b64_tr_b16 a[180:181], v134 offset:51200
    ds_read_b64_tr_b16 a[182:183], v134 offset:51456
    ds_read_b64_tr_b16 a[184:185], v134 offset:53248
    ds_read_b64_tr_b16 a[186:187], v134 offset:53504
    ds_read_b64_tr_b16 a[188:189], v134 offset:55296
    ds_read_b64_tr_b16 a[190:191], v134 offset:55552
    s_waitcnt lgkmcnt(4)
    s_waitcnt lgkmcnt(0)
    v_mfma_f32_16x16x32_bf16 v[144:147], a[128:131], v[96:99], 0
    v_mfma_f32_16x16x32_bf16 v[144:147], a[132:135], v[96:99], v[144:147]
    v_mfma_f32_16x16x32_bf16 v[144:147], a[136:139], v[96:99], v[144:147]
    v_mfma_f32_16x16x32_bf16 v[144:147], a[140:143], v[96:99], v[144:147]
    v_mfma_f32_16x16x32_bf16 v[144:147], a[144:147], v[96:99], v[144:147]
    v_mfma_f32_16x16x32_bf16 v[144:147], a[148:151], v[96:99], v[144:147]
    v_mfma_f32_16x16x32_bf16 v[144:147], a[152:155], v[96:99], v[144:147]
    v_mfma_f32_16x16x32_bf16 v[144:147], a[156:159], v[96:99], v[144:147]
    v_mfma_f32_16x16x32_bf16 v[144:147], a[160:163], v[96:99], v[144:147]
    v_mfma_f32_16x16x32_bf16 v[144:147], a[164:167], v[96:99], v[144:147]
    v_mfma_f32_16x16x32_bf16 v[144:147], a[168:171], v[96:99], v[144:147]
    v_mfma_f32_16x16x32_bf16 v[144:147], a[172:175], v[96:99], v[144:147]
    v_mfma_f32_16x16x32_bf16 v[144:147], a[176:179], v[96:99], v[144:147]
    v_mfma_f32_16x16x32_bf16 v[144:147], a[180:183], v[96:99], v[144:147]
    v_mfma_f32_16x16x32_bf16 v[144:147], a[184:187], v[96:99], v[144:147]
    v_mfma_f32_16x16x32_bf16 v[144:147], a[188:191], v[96:99], v[144:147]
    s_waitcnt vmcnt(0)
    v_xor_b32 v125, 0, v248
    v_add_u32 v125, s45, v125
    ds_read_b64_tr_b16 a[192:193], v125 offset:0
    ds_read_b64_tr_b16 a[194:195], v125 offset:1024
    v_xor_b32 v125, 64, v248
    v_add_u32 v125, s45, v125
    ds_read_b64_tr_b16 a[196:197], v125 offset:0
    ds_read_b64_tr_b16 a[198:199], v125 offset:1024
    v_xor_b32 v125, 0, v248
    v_add_u32 v125, s45, v125
    ds_read_b64_tr_b16 a[200:201], v125 offset:8
    ds_read_b64_tr_b16 a[202:203], v125 offset:1032
    v_xor_b32 v125, 64, v248
    v_add_u32 v125, s45, v125
    ds_read_b64_tr_b16 a[204:205], v125 offset:8
    ds_read_b64_tr_b16 a[206:207], v125 offset:1032
    s_waitcnt lgkmcnt(4)
    v_xor_b32 v125, 128, v248
    v_add_u32 v125, s45, v125
    ds_read_b64_tr_b16 a[208:209], v125 offset:0
    ds_read_b64_tr_b16 a[210:211], v125 offset:1024
    v_xor_b32 v125, 192, v248
    v_add_u32 v125, s45, v125
    ds_read_b64_tr_b16 a[212:213], v125 offset:0
    ds_read_b64_tr_b16 a[214:215], v125 offset:1024
    v_xor_b32 v125, 128, v248
    v_add_u32 v125, s45, v125
    ds_read_b64_tr_b16 a[216:217], v125 offset:8
    ds_read_b64_tr_b16 a[218:219], v125 offset:1032
    v_xor_b32 v125, 192, v248
    v_add_u32 v125, s45, v125
    ds_read_b64_tr_b16 a[220:221], v125 offset:8
    ds_read_b64_tr_b16 a[222:223], v125 offset:1032
    s_waitcnt lgkmcnt(4)
    v_permlane32_swap_b32 v144, v145
    v_permlane32_swap_b32 v146, v147
    v_cndmask_b32 v116, v144, v146, s[78:79]
    v_cndmask_b32 v117, v145, v147, s[78:79]
    s_branch L_t3s
L_fin:
L_end:
    s_endpgm
L_ls2:
    buffer_store_dwordx4 v[112:115], v127, s[36:39], s9 offen sc1
    s_branch L_le2
L_s58:
    s_waitcnt vmcnt(4)
    s_branch L_b58
L_s59:
    s_waitcnt vmcnt(4)
    s_branch L_b59
L_s60:
    s_waitcnt vmcnt(4)
    s_branch L_b60
L_s61:
    s_waitcnt vmcnt(4)
    s_branch L_b61
L_s62:
    s_waitcnt vmcnt(4)
    s_branch L_b62
L_s63:
    s_waitcnt vmcnt(4)
    s_branch L_b63
L_s64:
    s_waitcnt vmcnt(4)
    s_branch L_b64
L_s65:
    s_waitcnt vmcnt(4)
    s_branch L_b65
L_s66:
    s_waitcnt vmcnt(4)
    s_branch L_b66
L_s67:
    s_waitcnt vmcnt(4)
    s_branch L_b67
L_s68:
    s_waitcnt vmcnt(4)
    s_branch L_b68
L_s69:
    s_waitcnt vmcnt(4)
    s_branch L_b69
L_s70:
    s_waitcnt vmcnt(4)
    s_branch L_b70
L_s71:
    s_waitcnt vmcnt(4)
    s_branch L_b71
L_s72:
    s_waitcnt vmcnt(4)
    s_branch L_b72
L_s73:
    s_waitcnt vmcnt(4)
    s_branch L_b73
L_s74:
    s_waitcnt vmcnt(4)
    s_branch L_b74
L_s75:
    s_waitcnt vmcnt(4)
    s_branch L_b75
L_s76:
    s_waitcnt vmcnt(4)
    s_branch L_b76
L_s77:
    s_waitcnt vmcnt(4)
    s_branch L_b77
L_s78:
    s_waitcnt vmcnt(4)
    s_branch L_b78
L_s79:
    s_waitcnt vmcnt(4)
    s_branch L_b79
L_s80:
    s_waitcnt vmcnt(4)
    s_branch L_b80
L_s81:
    s_waitcnt vmcnt(4)
    s_branch L_b81
L_s82:
    s_waitcnt vmcnt(4)
    s_branch L_b82
L_s83:
    s_waitcnt vmcnt(4)
    s_branch L_b83
L_s84:
    s_waitcnt vmcnt(4)
    s_branch L_b84
L_s85:
    s_waitcnt vmcnt(4)
    s_branch L_b85
L_s86:
    s_waitcnt vmcnt(4)
    s_branch L_b86
L_s87:
    s_waitcnt vmcnt(4)
    s_branch L_b87
L_s88:
    s_waitcnt vmcnt(4)
    s_branch L_b88
L_s89:
    s_waitcnt vmcnt(4)
    s_branch L_b89
L_s90:
    s_waitcnt vmcnt(4)
    s_branch L_b90
L_s91:
    s_waitcnt vmcnt(4)
    s_branch L_b91
L_s92:
    s_waitcnt vmcnt(4)
    s_branch L_b92
L_s93:
    s_waitcnt vmcnt(4)
    s_branch L_b93
L_s94:
    s_waitcnt vmcnt(4)
    s_branch L_b94
L_s95:
    s_waitcnt vmcnt(4)
    s_branch L_b95
L_s96:
    s_waitcnt vmcnt(4)
    s_branch L_b96
L_s97:
    s_waitcnt vmcnt(4)
    s_branch L_b97
L_s98:
    s_waitcnt vmcnt(4)
    s_branch L_b98
L_s99:
    s_waitcnt vmcnt(4)
    s_branch L_b99
L_s100:
    s_waitcnt vmcnt(5)
    s_branch L_b100
L_s101:
    s_waitcnt vmcnt(5)
    s_branch L_b101
L_s102:
    s_waitcnt vmcnt(5)
    s_branch L_b102
L_s103:
    s_waitcnt vmcnt(5)
    s_branch L_b103
L_s104:
    s_waitcnt vmcnt(5)
    s_branch L_b104
L_s105:
    s_waitcnt vmcnt(4)
    s_branch L_b105
L_s106:
    s_waitcnt vmcnt(4)
    s_branch L_b106
L_s107:
    s_waitcnt vmcnt(4)
    s_branch L_b107
L_s108:
    s_waitcnt vmcnt(4)
    s_branch L_b108
L_s109:
    s_waitcnt vmcnt(4)
    s_branch L_b109
L_s110:
    s_waitcnt vmcnt(4)
    s_branch L_b110
L_s111:
    s_waitcnt vmcnt(4)
    s_branch L_b111
L_s112:
    s_waitcnt vmcnt(4)
    s_branch L_b112
L_s113:
    s_waitcnt vmcnt(4)
    s_branch L_b113
L_s114:
    s_waitcnt vmcnt(4)
    s_branch L_b114
L_s115:
    s_waitcnt vmcnt(4)
    s_branch L_b115
L_s116:
    s_waitcnt vmcnt(4)
    s_branch L_b116
L_s117:
    s_waitcnt vmcnt(4)
    s_branch L_b117
L_s118:
    s_waitcnt vmcnt(4)
    s_branch L_b118
L_s119:
    s_waitcnt vmcnt(4)
    s_branch L_b119
L_s120:
    s_waitcnt vmcnt(4)
    s_branch L_b120
L_s121:
    s_waitcnt vmcnt(4)
    s_branch L_b121
L_s122:
    s_waitcnt vmcnt(4)
    s_branch L_b122
L_s123:
    s_waitcnt vmcnt(4)
    s_branch L_b123
L_s124:
    s_waitcnt vmcnt(4)
    s_branch L_b124
L_s125:
    s_waitcnt vmcnt(4)
    s_branch L_b125
L_s126:
    s_waitcnt vmcnt(4)
    s_branch L_b126
L_s127:
    s_waitcnt vmcnt(4)
    s_branch L_b127
L_s128:
    s_waitcnt vmcnt(4)
    s_branch L_b128
L_s129:
    s_waitcnt vmcnt(4)
    s_branch L_b129
L_s130:
    s_waitcnt vmcnt(4)
    s_branch L_b130
L_s131:
    s_waitcnt vmcnt(4)
    s_branch L_b131
L_s132:
    s_waitcnt vmcnt(4)
    s_branch L_b132
L_s133:
    s_waitcnt vmcnt(4)
    s_branch L_b133
L_s134:
    s_waitcnt vmcnt(4)
    s_branch L_b134
L_s135:
    s_waitcnt vmcnt(4)
    s_branch L_b135
L_s136:
    s_waitcnt vmcnt(4)
    s_branch L_b136
L_s137:
    s_waitcnt vmcnt(4)
    s_branch L_b137
L_s138:
    s_waitcnt vmcnt(4)
    s_branch L_b138
L_s139:
    s_waitcnt vmcnt(4)
    s_branch L_b139
L_s140:
    s_waitcnt vmcnt(4)
    s_branch L_b140
L_s141:
    s_waitcnt vmcnt(4)
    s_branch L_b141
L_s142:
    s_waitcnt vmcnt(4)
    s_branch L_b142
L_s143:
    s_waitcnt vmcnt(4)
    s_branch L_b143
L_s144:
    s_waitcnt vmcnt(4)
    s_branch L_b144
L_s145:
    s_waitcnt vmcnt(4)
    s_branch L_b145
L_s146:
    s_waitcnt vmcnt(4)
    s_branch L_b146
L_s147:
    s_waitcnt vmcnt(4)
    s_branch L_b147
L_s148:
    s_waitcnt vmcnt(4)
    s_branch L_b148
L_s149:
    s_waitcnt vmcnt(4)
    s_branch L_b149
L_s150:
    s_waitcnt vmcnt(4)
    s_branch L_b150
L_s151:
    s_waitcnt vmcnt(4)
    s_branch L_b151
L_s152:
    s_waitcnt vmcnt(4)
    s_branch L_b152
L_s153:
    s_waitcnt vmcnt(4)
    s_branch L_b153
L_s154:
    s_waitcnt vmcnt(4)
    s_branch L_b154
L_s155:
    s_waitcnt vmcnt(4)
    s_branch L_b155
L_s156:
    s_waitcnt vmcnt(4)
    s_branch L_b156
L_s157:
    s_waitcnt vmcnt(4)
    s_branch L_b157
L_s158:
    s_waitcnt vmcnt(4)
    s_branch L_b158
L_s159:
    s_waitcnt vmcnt(4)
    s_branch L_b159
L_s160:
    s_waitcnt vmcnt(4)
    s_branch L_b160
L_s161:
    s_waitcnt vmcnt(4)
    s_branch L_b161
L_s162:
    s_waitcnt vmcnt(4)
    s_branch L_b162
L_s163:
    s_waitcnt vmcnt(4)
    s_branch L_b163
L_s164:
    s_waitcnt vmcnt(4)
    s_branch L_b164
L_s165:
    s_waitcnt vmcnt(4)
    s_branch L_b165
L_s166:
    s_waitcnt vmcnt(4)
    s_branch L_b166
L_s167:
    s_waitcnt vmcnt(4)
    s_branch L_b167
L_s168:
    s_waitcnt vmcnt(4)
    s_branch L_b168
L_s169:
    s_waitcnt vmcnt(5)
    s_branch L_b169
L_s170:
    s_waitcnt vmcnt(5)
    s_branch L_b170
L_s171:
    s_waitcnt vmcnt(5)
    s_branch L_b171
L_s172:
    s_waitcnt vmcnt(5)
    s_branch L_b172
L_s173:
    s_waitcnt vmcnt(5)
    s_branch L_b173
L_s174:
    s_waitcnt vmcnt(4)
    s_branch L_b174
L_s175:
    s_waitcnt vmcnt(4)
    s_branch L_b175
L_s176:
    s_waitcnt vmcnt(4)
    s_branch L_b176
L_s177:
    s_waitcnt vmcnt(4)
    s_branch L_b177
L_s178:
    s_waitcnt vmcnt(4)
    s_branch L_b178
L_s179:
    s_waitcnt vmcnt(4)
    s_branch L_b179
L_s180:
    s_waitcnt vmcnt(4)
    s_branch L_b180
L_s181:
    s_waitcnt vmcnt(4)
    s_branch L_b181
L_s182:
    s_waitcnt vmcnt(4)
    s_branch L_b182
L_s183:
    s_waitcnt vmcnt(4)
    s_branch L_b183
L_s184:
    s_waitcnt vmcnt(4)
    s_branch L_b184
L_s185:
    s_waitcnt vmcnt(4)
    s_branch L_b185
L_s186:
    s_waitcnt vmcnt(4)
    s_branch L_b186
L_s187:
    s_waitcnt vmcnt(4)
    s_branch L_b187
L_s188:
    s_waitcnt vmcnt(4)
    s_branch L_b188
L_s189:
    s_waitcnt vmcnt(4)
    s_branch L_b189
L_s190:
    s_waitcnt vmcnt(4)
    s_branch L_b190
L_s191:
    s_waitcnt vmcnt(4)
    s_branch L_b191
L_s192:
    s_waitcnt vmcnt(4)
    s_branch L_b192
L_s193:
    s_waitcnt vmcnt(4)
    s_branch L_b193
L_s194:
    s_waitcnt vmcnt(4)
    s_branch L_b194
L_s195:
    s_waitcnt vmcnt(4)
    s_branch L_b195
L_s196:
    s_waitcnt vmcnt(4)
    s_branch L_b196
L_s197:
    s_waitcnt vmcnt(4)
    s_branch L_b197
L_s198:
    s_waitcnt vmcnt(4)
    s_branch L_b198
L_s199:
    s_waitcnt vmcnt(4)
    s_branch L_b199
L_s200:
    s_waitcnt vmcnt(4)
    s_branch L_b200
L_s201:
    s_waitcnt vmcnt(4)
    s_branch L_b201
L_s202:
    s_waitcnt vmcnt(4)
    s_branch L_b202
L_s203:
    s_waitcnt vmcnt(4)
    s_branch L_b203
L_s204:
    s_waitcnt vmcnt(4)
    s_branch L_b204
L_s205:
    s_waitcnt vmcnt(4)
    s_branch L_b205
L_s206:
    s_waitcnt vmcnt(4)
    s_branch L_b206
L_s207:
    s_waitcnt vmcnt(4)
    s_branch L_b207
L_s208:
    s_waitcnt vmcnt(4)
    s_branch L_b208
L_s209:
    s_waitcnt vmcnt(4)
    s_branch L_b209
L_s210:
    s_waitcnt vmcnt(4)
    s_branch L_b210
L_s211:
    s_waitcnt vmcnt(4)
    s_branch L_b211
L_s212:
    s_waitcnt vmcnt(4)
    s_branch L_b212
L_s213:
    s_waitcnt vmcnt(4)
    s_branch L_b213
L_s214:
    s_waitcnt vmcnt(4)
    s_branch L_b214
L_s215:
    s_waitcnt vmcnt(5)
    s_branch L_b215
L_s216:
    s_waitcnt vmcnt(5)
    s_branch L_b216
L_s217:
    s_waitcnt vmcnt(5)
    s_branch L_b217
L_s218:
    s_waitcnt vmcnt(5)
    s_branch L_b218
L_s219:
    s_waitcnt vmcnt(5)
    s_branch L_b219
L_s220:
    s_waitcnt vmcnt(4)
    s_branch L_b220
L_s221:
    s_waitcnt vmcnt(4)
    s_branch L_b221
L_s222:
    s_waitcnt vmcnt(4)
    s_branch L_b222
L_s223:
    s_waitcnt vmcnt(4)
    s_branch L_b223
L_s224:
    s_waitcnt vmcnt(4)
    s_branch L_b224
L_s225:
    s_waitcnt vmcnt(4)
    s_branch L_b225
L_s226:
    s_waitcnt vmcnt(4)
    s_branch L_b226
L_s227:
    s_waitcnt vmcnt(4)
    s_branch L_b227
L_s228:
    s_waitcnt vmcnt(4)
    s_branch L_b228
L_s229:
    s_waitcnt vmcnt(4)
    s_branch L_b229
L_s230:
    s_waitcnt vmcnt(4)
    s_branch L_b230
L_s231:
    s_waitcnt vmcnt(4)
    s_branch L_b231
L_s232:
    s_waitcnt vmcnt(4)
    s_branch L_b232
L_s233:
    s_waitcnt vmcnt(4)
    s_branch L_b233
L_s234:
    s_waitcnt vmcnt(4)
    s_branch L_b234
L_s235:
    s_waitcnt vmcnt(4)
    s_branch L_b235
L_s236:
    s_waitcnt vmcnt(4)
    s_branch L_b236
L_s237:
    s_waitcnt vmcnt(4)
    s_branch L_b237
L_s238:
    s_waitcnt vmcnt(4)
    s_branch L_b238
L_s239:
    s_waitcnt vmcnt(4)
    s_branch L_b239
L_s240:
    s_waitcnt vmcnt(4)
    s_branch L_b240
L_s241:
    s_waitcnt vmcnt(4)
    s_branch L_b241
L_s242:
    s_waitcnt vmcnt(4)
    s_branch L_b242
L_s243:
    s_waitcnt vmcnt(4)
    s_branch L_b243
L_s244:
    s_waitcnt vmcnt(4)
    s_branch L_b244
L_s245:
    s_waitcnt vmcnt(4)
    s_branch L_b245
L_s246:
    s_waitcnt vmcnt(4)
    s_branch L_b246
L_s247:
    s_waitcnt vmcnt(4)
    s_branch L_b247
L_s248:
    s_waitcnt vmcnt(4)
    s_branch L_b248
L_s249:
    s_waitcnt vmcnt(4)
    s_branch L_b249
L_s250:
    s_waitcnt vmcnt(4)
    s_branch L_b250
L_s251:
    s_waitcnt vmcnt(4)
    s_branch L_b251
L_s252:
    s_waitcnt vmcnt(4)
    s_branch L_b252
L_s253:
    s_waitcnt vmcnt(4)
    s_branch L_b253
L_s254:
    s_waitcnt vmcnt(4)
    s_branch L_b254
L_s255:
    s_waitcnt vmcnt(4)
    s_branch L_b255
L_s256:
    s_waitcnt vmcnt(6)
    s_branch L_b256
L_s257:
    s_waitcnt vmcnt(6)
    s_branch L_b257
L_s258:
    s_waitcnt vmcnt(6)
    s_branch L_b258
L_s259:
    s_waitcnt vmcnt(6)
    s_branch L_b259
L_s260:
    s_waitcnt vmcnt(6)
    s_branch L_b260
L_s261:
    s_waitcnt vmcnt(6)
    s_branch L_b261
L_s262:
    s_waitcnt vmcnt(6)
    s_branch L_b262
L_s263:
    s_waitcnt vmcnt(6)
    s_branch L_b263
L_s264:
    s_waitcnt vmcnt(6)
    s_branch L_b264
L_s265:
    s_waitcnt vmcnt(6)
    s_branch L_b265
L_s266:
    s_waitcnt vmcnt(6)
    s_branch L_b266
L_s267:
    s_waitcnt vmcnt(6)
    s_branch L_b267
L_s268:
    s_waitcnt vmcnt(6)
    s_branch L_b268
L_s269:
    s_waitcnt vmcnt(6)
    s_branch L_b269
L_s270:
    s_waitcnt vmcnt(6)
    s_branch L_b270
L_s271:
    s_waitcnt vmcnt(6)
    s_branch L_b271
L_qretry:
    s_add_u32 s74, s74, 1
    s_cmp_ge_u32 s74, 200000
    s_cbranch_scc1 L_qok
    buffer_load_dwordx4 v[188:191], v138, s[36:39], s9 offen offset:0 sc1
    buffer_load_dwordx4 v[192:195], v138, s[36:39], s9 offen offset:16 sc1
    buffer_load_dwordx4 v[196:199], v138, s[36:39], s9 offen offset:256 sc1
    buffer_load_dwordx4 v[200:203], v138, s[36:39], s9 offen offset:272 sc1
    s_waitcnt vmcnt(0)
    s_branch L_qchk
L_ls4:
    buffer_store_dwordx4 v[220:223], v127, s[36:39], s7 offen sc1
    s_branch L_le4
L_mlretry:
    s_add_u32 s74, s74, 1
    s_cmp_ge_u32 s74, 200000
    s_cbranch_scc1 L_mlok
    buffer_load_dwordx4 v[188:191], v139, s[36:39], s9 offen sc1
    s_waitcnt vmcnt(0)
    s_branch L_mlchk
L_adrain:
    s_add_u32 m0, s47, 0
    s_nop 0
    buffer_load_dwordx4 v224, s[52:55], s46 offen  lds
    s_add_u32 m0, s47, 8192
    s_nop 0
    buffer_load_dwordx4 v225, s[56:59], s46 offen  lds
    s_add_u32 s46, s46, 57344
    s_add_u32 m0, s47, 1024
    s_nop 0
    buffer_load_dwordx4 v224, s[52:55], s46 offen  lds
    s_add_u32 m0, s47, 9216
    s_nop 0
    buffer_load_dwordx4 v225, s[56:59], s46 offen  lds
    s_add_u32 s46, s46, 57344
    s_waitcnt vmcnt(9)
    v_mfma_f32_16x16x32_bf16 v[108:111], v[100:103], a[40:43], v[108:111]
    v_mfma_f32_16x16x32_bf16 v[112:115], v[104:107], a[40:43], v[112:115]
    v_perm_b32 v100, v159, v159, v8
    v_perm_b32 v101, v159, v159, v9
    v_perm_b32 v102, v159, v159, v10
    v_perm_b32 v103, v159, v159, v11
    v_perm_b32 v104, v159, v159, v12
    v_perm_b32 v105, v159, v159, v13
    v_perm_b32 v106, v159, v159, v14
    v_perm_b32 v107, v159, v159, v15
    s_waitcnt vmcnt(8)
    v_mfma_f32_16x16x32_bf16 v[108:111], v[100:103], a[44:47], v[108:111]
    v_mfma_f32_16x16x32_bf16 v[112:115], v[104:107], a[44:47], v[112:115]
    v_perm_b32 v100, v160, v160, v8
    v_perm_b32 v101, v160, v160, v9
    v_perm_b32 v102, v160, v160, v10
    v_perm_b32 v103, v160, v160, v11
    v_perm_b32 v104, v160, v160, v12
    v_perm_b32 v105, v160, v160, v13
    v_perm_b32 v106, v160, v160, v14
    v_perm_b32 v107, v160, v160, v15
    s_waitcnt vmcnt(7)
    v_mfma_f32_16x16x32_bf16 v[108:111], v[100:103], a[48:51], v[108:111]
    v_mfma_f32_16x16x32_bf16 v[112:115], v[104:107], a[48:51], v[112:115]
    v_perm_b32 v100, v161, v161, v8
    v_perm_b32 v101, v161, v161, v9
    v_perm_b32 v102, v161, v161, v10
    v_perm_b32 v103, v161, v161, v11
    v_perm_b32 v104, v161, v161, v12
    v_perm_b32 v105, v161, v161, v13
    v_perm_b32 v106, v161, v161, v14
    v_perm_b32 v107, v161, v161, v15
    s_waitcnt vmcnt(6)
    v_mfma_f32_16x16x32_bf16 v[108:111], v[100:103], a[52:55], v[108:111]
    v_mfma_f32_16x16x32_bf16 v[112:115], v[104:107], a[52:55], v[112:115]
    v_perm_b32 v100, v162, v162, v8
    v_perm_b32 v101, v162, v162, v9
    v_perm_b32 v102, v162, v162, v10
    v_perm_b32 v103, v162, v162, v11
    v_perm_b32 v104, v162, v162, v12
    v_perm_b32 v105, v162, v162, v13
    v_perm_b32 v106, v162, v162, v14
    v_perm_b32 v107, v162, v162, v15
    s_waitcnt vmcnt(5)
    v_mfma_f32_16x16x32_bf16 v[108:111], v[100:103], a[56:59], v[108:111]
    v_mfma_f32_16x16x32_bf16 v[112:115], v[104:107], a[56:59], v[112:115]
    v_perm_b32 v100, v163, v163, v8
    v_perm_b32 v101, v163, v163, v9
    v_perm_b32 v102, v163, v163, v10
    v_perm_b32 v103, v163, v163, v11
    v_perm_b32 v104, v163, v163, v12
    v_perm_b32 v105, v163, v163, v13
    v_perm_b32 v106, v163, v163, v14
    v_perm_b32 v107, v163, v163, v15
    s_waitcnt vmcnt(4)
    v_mfma_f32_16x16x32_bf16 v[108:111], v[100:103], a[60:63], v[108:111]
    v_mfma_f32_16x16x32_bf16 v[112:115], v[104:107], a[60:63], v[112:115]
    v_perm_b32 v100, v164, v164, v8
    v_perm_b32 v101, v164, v164, v9
    v_perm_b32 v102, v164, v164, v10
    v_perm_b32 v103, v164, v164, v11
    v_perm_b32 v104, v164, v164, v12
    v_perm_b32 v105, v164, v164, v13
    v_perm_b32 v106, v164, v164, v14
    v_perm_b32 v107, v164, v164, v15
    s_getpc_b64 s[0:1]
L_pca:
    s_sub_u32 s0, s0, L_pca-L_tail
    s_subb_u32 s1, s1, 0
    v_lshlrev_b32 v135, 4, v0
    global_load_dwordx4 v[228:231], v135, s[0:1]
    s_nop 7
    s_branch L_tail
L_ls5:
    buffer_store_dwordx2 v[88:89], v235, s[36:39], s13 offen sc1
    s_branch L_le5
L_ls6:
    buffer_store_dword v96, v241, s[36:39], s18 offen sc1
    s_branch L_le6
.rept 520
 s_endpgm
.endr
.section .rodata,"a"
.p2align 6
.amdhsa_kernel sequential_preLN__gqa_block_cached__geglu_ffn__decode_kernel
  .amdhsa_next_free_vgpr 512
  .amdhsa_next_free_sgpr 102
  .amdhsa_accum_offset 256
  .amdhsa_group_segment_fixed_size 0
  .amdhsa_kernarg_size 96
  .amdhsa_user_sgpr_count 2
  .amdhsa_user_sgpr_kernarg_segment_ptr 1
  .amdhsa_system_sgpr_workgroup_id_x 1
  .amdhsa_float_denorm_mode_32 3
.end_amdhsa_kernel
```
